```python
import torch

def _softmax(x, axis=-1):
    return torch.softmax(x, dim=axis)
def _gelu(x):
    return torch.nn.functional.gelu(x, approximate="tanh")
def _silu(x):
    return torch.nn.functional.silu(x)
def _sigmoid(x):
    return torch.sigmoid(x)
def _layernorm(x, axis=-1, eps=1e-5):
    m = x.mean(dim=axis, keepdim=True)
    v = x.var(dim=axis, keepdim=True, unbiased=False)
    return (x - m) / torch.sqrt(v + eps)
def _scatter_add(tgt, idx, src, axis=0):
    return tgt.clone().index_add_(axis, idx, src)
def _segment_sum(src, seg, n):
    out = torch.zeros((n,) + src.shape[1:], dtype=src.dtype)
    return out.index_add_(0, seg, src)
def _pad(x, pw):
    flat = tuple(v for pair in reversed(pw) for v in pair)
    return torch.nn.functional.pad(x, flat)

kernel_name = 'interleave_layers__spectral_fnet__glu_gated_glu__prompt'

def setup_inputs():

    _w = (lambda a: (lambda t: t.to(torch.bfloat16) if t.is_floating_point() else t)(torch.as_tensor(a)))
    def _A_setup():
        B, S, D = 1, 2048, 640
        ns = torch.arange(S)[:, None] * torch.arange(S)[None, :]
        nd = torch.arange(D)[:, None] * torch.arange(D)[None, :]
        Ws_re = torch.cos(-2.0 * torch.pi * ns / S).to(float)
        Ws_im = torch.sin(-2.0 * torch.pi * ns / S).to(float)
        Wd_re = torch.cos(-2.0 * torch.pi * nd / D).to(float)
        Wd_im = torch.sin(-2.0 * torch.pi * nd / D).to(float)
        return {
            "x": _w((lambda *s: torch.randn(*s, dtype=torch.bfloat16) * 0.05)(B, S, D)),
            "dft_seq_re": _w(Ws_re),
            "dft_seq_im": _w(Ws_im),
            "dft_hid_re": _w(Wd_re),
            "dft_hid_im": _w(Wd_im),
        }
    _A_in = _A_setup()

    def _B_setup():
        B, S, D, F = 1, 2048, 640, 1728
        return {
            "x": _w((lambda *s: torch.randn(*s, dtype=torch.bfloat16) * 0.05)(B, S, D)),
            "w_gate": _w((lambda *s: torch.randn(*s, dtype=torch.bfloat16) * 1.6)(D, F)),
            "w_up": _w((lambda *s: torch.randn(*s, dtype=torch.bfloat16) * 0.8)(D, F)),
            "w_down": _w((lambda *s: torch.randn(*s, dtype=torch.bfloat16) * 0.8)(F, D)),
        }
    _B_in = _B_setup()

    return {
        "A_x": _A_in["x"],
        "A_dft_seq_re": _A_in["dft_seq_re"],
        "A_dft_seq_im": _A_in["dft_seq_im"],
        "A_dft_hid_re": _A_in["dft_hid_re"],
        "A_dft_hid_im": _A_in["dft_hid_im"],
        "B_x": _B_in["x"],
        "B_w_gate": _B_in["w_gate"],
        "B_w_up": _B_in["w_up"],
        "B_w_down": _B_in["w_down"],
    }

def reference(A_x, A_dft_seq_re, A_dft_seq_im, A_dft_hid_re, A_dft_hid_im, B_x, B_w_gate, B_w_up, B_w_down):
    def _A_ref(x, dft_seq_re, dft_seq_im, dft_hid_re, dft_hid_im):
        a = torch.einsum("bsd,ed->bse", x, dft_hid_re)
        b = torch.einsum("bsd,ed->bse", x, dft_hid_im)
        y = torch.einsum("ts,bse->bte", dft_seq_re, a) - torch.einsum("ts,bse->bte", dft_seq_im, b)
        return y

    def _B_ref(x, w_gate, w_up, w_down):
        g = torch.einsum("bsd,df->bsf", x, w_gate)
        u = torch.einsum("bsd,df->bsf", x, w_up)
        h = _sigmoid(g) * u
        return torch.einsum("bsf,fd->bsd", h, w_down)

    x = A_x
    x = x + _A_ref(_layernorm(x, axis=-1), A_dft_seq_re, A_dft_seq_im, A_dft_hid_re, A_dft_hid_im)
    x = x + _B_ref(_layernorm(x, axis=-1), B_w_gate, B_w_up, B_w_down)
    x = x + _A_ref(_layernorm(x, axis=-1), A_dft_seq_re, A_dft_seq_im, A_dft_hid_re, A_dft_hid_im)
    x = x + _B_ref(_layernorm(x, axis=-1), B_w_gate, B_w_up, B_w_down)
    return x
```

```asm
; @launch kernel=l1_kernel grid=(459,1,1) block=(256,1,1) lds=67072
; @launch kernel=l2_kernel grid=(256,1,1) block=(256,1,1) lds=140800
.amdgcn_target "amdgcn-amd-amdhsa--gfx950"
.text
.globl l1_kernel
.p2align 8
.type l1_kernel,@function
l1_kernel:
s_cmp_ge_u32 s2, 459
s_cbranch_scc1 l1_kernel_end
s_load_dwordx2 s[4:5], s[0:1], 88
s_load_dwordx2 s[6:7], s[0:1], 0
s_load_dwordx2 s[44:45], s[0:1], 48
s_load_dwordx2 s[46:47], s[0:1], 56
s_load_dwordx2 s[48:49], s[0:1], 64
v_lshrrev_b32 v1, 6, v0
s_nop 0
v_readfirstlane_b32 s20, v1
s_cmp_ge_u32 s2, 256
s_cbranch_scc1 l1_kernel_prep
s_getpc_b64 s[50:51]
l1_kernel_pc2_3408_12:
s_sub_u32 s50, s50, l1_kernel_pc2_3408_12-l1_kernel
s_subb_u32 s51, s51, 0
v_lshlrev_b32 v2, 4, v0
v_min_u32 v3, l1_kernel_end-l1_kernel-16, v2
global_load_dwordx4 v[244:247], v3, s[50:51]
v_add_u32 v2, 4096, v2
v_min_u32 v3, l1_kernel_end-l1_kernel-16, v2
global_load_dwordx4 v[244:247], v3, s[50:51]
v_add_u32 v2, 4096, v2
v_min_u32 v3, l1_kernel_end-l1_kernel-16, v2
global_load_dwordx4 v[244:247], v3, s[50:51]
v_add_u32 v2, 4096, v2
v_min_u32 v3, l1_kernel_end-l1_kernel-16, v2
global_load_dwordx4 v[244:247], v3, s[50:51]
v_add_u32 v2, 4096, v2
s_and_b32 s21, s2, 7
s_lshl_b32 s21, s21, 3
s_lshr_b32 s22, s2, 5
s_add_u32 s21, s21, s22
s_bfe_u32 s22, s2, 0x20003
s_lshr_b32 s24, s21, 2
s_sub_u32 s25, 16, s24
s_and_b32 s25, s25, 15
s_bitcmp1_b32 s21, 1
s_cselect_b32 s24, s25, s24
s_and_b32 s25, s21, 1
s_lshl_b32 s25, s25, 5
s_add_u32 s24, s24, s25
s_and_b32 s25, s21, 2
s_lshl_b32 s25, s25, 3
s_add_u32 s23, s24, s25
s_waitcnt lgkmcnt(0)
s_mov_b32 s8, s4
s_mov_b32 s9, s5
s_mov_b32 s10, 268435456
s_mov_b32 s11, 0x20000
s_mov_b32 s12, s6
s_mov_b32 s13, s7
s_mov_b32 s14, 2621440
s_mov_b32 s15, 0x20000
v_and_b32 v4, 63, v0
v_lshlrev_b32 v1, 4, v4
v_and_b32 v2, 31, v0
v_bfe_u32 v3, v0, 5, 1
v_bfe_u32 v4, v0, 3, 3
s_lshl_b32 s3, s20, 3
v_add_u32 v11, s3, v4
v_lshlrev_b32 v4, 6, v11
v_add_u32 v4, s23, v4
v_mul_u32_u24 v4, 1280, v4
v_and_b32 v12, 7, v0
v_lshl_add_u32 v5, v12, 4, v4
v_add_u32 v6, 640, v4
v_add_u32 v7, 1168, v5
v_cmp_eq_u32 vcc, 7, v12
s_nop 1
v_cndmask_b32 v6, v7, v6, vcc
buffer_load_dwordx4 v[64:67], v5, s[12:15], 0 offen offset:0
buffer_load_dwordx4 v[68:71], v5, s[12:15], 0 offen offset:128
buffer_load_dwordx4 v[72:75], v5, s[12:15], 0 offen offset:256
buffer_load_dwordx4 v[76:79], v5, s[12:15], 0 offen offset:384
buffer_load_dwordx4 v[80:83], v5, s[12:15], 0 offen offset:512
buffer_load_dwordx4 v[84:87], v5, s[12:15], 0 offen offset:640
buffer_load_dwordx4 v[88:91], v5, s[12:15], 0 offen offset:768
buffer_load_dwordx4 v[92:95], v5, s[12:15], 0 offen offset:896
buffer_load_dwordx4 v[96:99], v5, s[12:15], 0 offen offset:1024
buffer_load_dwordx4 v[100:103], v5, s[12:15], 0 offen offset:1152
buffer_load_dword v104, v5, s[12:15], 0 offen offset:656
buffer_load_dword v105, v5, s[12:15], 0 offen offset:784
buffer_load_dword v106, v5, s[12:15], 0 offen offset:912
buffer_load_dword v107, v5, s[12:15], 0 offen offset:1040
buffer_load_dword v108, v6, s[12:15], 0 offen
s_cmp_lg_u32 s20, 0
s_cbranch_scc1 l1_kernel_c2
s_getpc_b64 s[50:51]
l1_kernel_c2pc:
s_add_u32 s50, s50, l2_kernel-l1_kernel_c2pc
s_addc_u32 s51, s51, 0
s_lshr_b32 s3, s2, 3
s_lshl_b32 s3, s3, 10
v_add_u32 v6, s3, v1
v_min_u32 v6, l2_kernel_end-l2_kernel-16, v6
global_load_dwordx4 v[244:247], v6, s[50:51]
l1_kernel_c2:
v_mov_b32 v251, v11
v_mov_b32 v252, v12
v_cvt_f32_u32 v4, v2
v_mul_f32 v4, 0x3a000000, v4
v_lshlrev_b32 v5, 8, v3
v_add_u32 v5, s23, v5
v_cvt_f32_u32 v5, v5
v_mul_f32 v5, v4, v5
v_mul_f32 v4, 0x42800000, v4
v_mov_b32 v8, 0x0
v_fma_f32 v6, v8, v4, v5
v_mov_b32 v8, 0x3f800000
v_fma_f32 v7, v8, v4, v5
v_cos_f32 v8, v6
v_cos_f32 v9, v7
v_sin_f32 v10, -v6
v_sin_f32 v11, -v7
v_cvt_pk_f16_f32 v16, v8, v9
v_cvt_pk_f16_f32 v24, v10, v11
v_mov_b32 v8, 0x40000000
v_fma_f32 v6, v8, v4, v5
v_mov_b32 v8, 0x40400000
v_fma_f32 v7, v8, v4, v5
v_cos_f32 v8, v6
v_cos_f32 v9, v7
v_sin_f32 v10, -v6
v_sin_f32 v11, -v7
v_cvt_pk_f16_f32 v17, v8, v9
v_cvt_pk_f16_f32 v25, v10, v11
v_mov_b32 v8, 0x41000000
v_fma_f32 v6, v8, v4, v5
v_mov_b32 v8, 0x41100000
v_fma_f32 v7, v8, v4, v5
v_cos_f32 v8, v6
v_cos_f32 v9, v7
v_sin_f32 v10, -v6
v_sin_f32 v11, -v7
v_cvt_pk_f16_f32 v18, v8, v9
v_cvt_pk_f16_f32 v26, v10, v11
v_mov_b32 v8, 0x41200000
v_fma_f32 v6, v8, v4, v5
v_mov_b32 v8, 0x41300000
v_fma_f32 v7, v8, v4, v5
v_cos_f32 v8, v6
v_cos_f32 v9, v7
v_sin_f32 v10, -v6
v_sin_f32 v11, -v7
v_cvt_pk_f16_f32 v19, v8, v9
v_cvt_pk_f16_f32 v27, v10, v11
v_mov_b32 v8, 0x41800000
v_fma_f32 v6, v8, v4, v5
v_mov_b32 v8, 0x41880000
v_fma_f32 v7, v8, v4, v5
v_cos_f32 v8, v6
v_cos_f32 v9, v7
v_sin_f32 v10, -v6
v_sin_f32 v11, -v7
v_cvt_pk_f16_f32 v20, v8, v9
v_cvt_pk_f16_f32 v28, v10, v11
v_mov_b32 v8, 0x41900000
v_fma_f32 v6, v8, v4, v5
v_mov_b32 v8, 0x41980000
v_fma_f32 v7, v8, v4, v5
v_cos_f32 v8, v6
v_cos_f32 v9, v7
v_sin_f32 v10, -v6
v_sin_f32 v11, -v7
v_cvt_pk_f16_f32 v21, v8, v9
v_cvt_pk_f16_f32 v29, v10, v11
v_mov_b32 v8, 0x41c00000
v_fma_f32 v6, v8, v4, v5
v_mov_b32 v8, 0x41c80000
v_fma_f32 v7, v8, v4, v5
v_cos_f32 v8, v6
v_cos_f32 v9, v7
v_sin_f32 v10, -v6
v_sin_f32 v11, -v7
v_cvt_pk_f16_f32 v22, v8, v9
v_cvt_pk_f16_f32 v30, v10, v11
v_mov_b32 v8, 0x41d00000
v_fma_f32 v6, v8, v4, v5
v_mov_b32 v8, 0x41d80000
v_fma_f32 v7, v8, v4, v5
v_cos_f32 v8, v6
v_cos_f32 v9, v7
v_sin_f32 v10, -v6
v_sin_f32 v11, -v7
v_cvt_pk_f16_f32 v23, v8, v9
v_cvt_pk_f16_f32 v31, v10, v11
v_and_b32 v4, 0x31, v0
v_cmp_eq_u32 vcc, 1, v4
v_mov_b32 v5, 0xc000
v_mov_b32 v6, 0xbf00
v_cndmask_b32 v228, 0, v5, vcc
v_cndmask_b32 v232, 0, v6, vcc
v_mov_b32 v229, 0
v_mov_b32 v233, 0
v_mov_b32 v230, 0
v_mov_b32 v234, 0
v_mov_b32 v231, 0
v_mov_b32 v235, 0
v_mul_u32_u24 v4, 1296, v2
v_lshl_add_u32 v253, v3, 4, v4
s_add_u32 s3, s20, 0
s_and_b32 s3, s3, 3
s_mul_i32 s3, s3, 160
v_add_u32 v236, s3, v253
s_add_u32 s3, s20, 1
s_and_b32 s3, s3, 3
s_mul_i32 s3, s3, 160
v_add_u32 v237, s3, v253
s_add_u32 s3, s20, 2
s_and_b32 s3, s3, 3
s_mul_i32 s3, s3, 160
v_add_u32 v238, s3, v253
s_add_u32 s3, s20, 3
s_and_b32 s3, s3, 3
s_mul_i32 s3, s3, 160
v_add_u32 v239, s3, v253
s_mul_i32 s3, s22, 5
s_add_u32 s4, s3, s20
s_lshl_b32 s4, s4, 4
v_and_b32 v4, 15, v2
v_add_u32 v4, s4, v4
v_cmp_eq_u32 vcc, 0, v4
v_mov_b32 v5, 320
s_nop 0
v_cndmask_b32 v4, v4, v5, vcc
v_cvt_f32_u32 v109, v4
v_cvt_f32_u32 v5, v3
v_mul_f32 v5, 0x41000000, v5
v_mul_f32 v110, v5, v109
v_mul_f32 v111, 0x3acccccd, v109
v_cos_f32 v112, v111
v_cmp_lt_u32 vcc, 15, v2
v_mov_b32 v5, 0x3e800000
s_nop 0
v_cndmask_b32 v113, 0, v5, vcc
v_add_f32 v112, v112, v112
s_mov_b32 s5, 0x3acccccd
s_add_u32 s3, s20, 0
s_and_b32 s3, s3, 3
s_mul_i32 s3, s3, 80
v_cvt_f32_u32 v6, s3
v_fma_f32 v6, v6, v109, v110
v_mov_b32 v114, v6
s_mov_b32 s6, 0x41800000
v_fma_f32 v115, s6, v109, v6
s_mov_b32 s6, 0x42000000
v_fma_f32 v116, s6, v109, v6
s_mov_b32 s6, 0x42400000
v_fma_f32 v117, s6, v109, v6
s_mov_b32 s6, 0x42800000
v_fma_f32 v118, s6, v109, v6
v_fma_f32 v114, v114, s5, v113
v_fma_f32 v115, v115, s5, v113
v_fma_f32 v116, v116, s5, v113
v_fma_f32 v117, v117, s5, v113
v_fma_f32 v118, v118, s5, v113
v_fract_f32 v114, v114
v_fract_f32 v115, v115
v_fract_f32 v116, v116
v_fract_f32 v117, v117
v_fract_f32 v118, v118
v_cos_f32 v32, v114
v_cos_f32 v40, v115
v_cos_f32 v48, v116
v_cos_f32 v56, v117
v_cos_f32 v119, v118
v_add_f32 v114, v114, v111
v_add_f32 v115, v115, v111
v_add_f32 v116, v116, v111
v_add_f32 v117, v117, v111
v_add_f32 v118, v118, v111
v_cos_f32 v33, v114
v_cos_f32 v41, v115
v_cos_f32 v49, v116
v_cos_f32 v57, v117
v_cos_f32 v120, v118
v_fma_f32 v34, v112, v33, -v32
v_fma_f32 v42, v112, v41, -v40
v_fma_f32 v50, v112, v49, -v48
v_fma_f32 v58, v112, v57, -v56
v_fma_f32 v121, v112, v120, -v119
v_fma_f32 v35, v112, v34, -v33
v_fma_f32 v43, v112, v42, -v41
v_fma_f32 v51, v112, v50, -v49
v_fma_f32 v59, v112, v58, -v57
v_fma_f32 v122, v112, v121, -v120
v_fma_f32 v36, v112, v35, -v34
v_fma_f32 v44, v112, v43, -v42
v_fma_f32 v52, v112, v51, -v50
v_fma_f32 v60, v112, v59, -v58
v_fma_f32 v123, v112, v122, -v121
v_fma_f32 v37, v112, v36, -v35
v_fma_f32 v45, v112, v44, -v43
v_fma_f32 v53, v112, v52, -v51
v_fma_f32 v61, v112, v60, -v59
v_fma_f32 v124, v112, v123, -v122
v_fma_f32 v38, v112, v37, -v36
v_fma_f32 v46, v112, v45, -v44
v_fma_f32 v54, v112, v53, -v52
v_fma_f32 v62, v112, v61, -v60
v_fma_f32 v125, v112, v124, -v123
v_fma_f32 v39, v112, v38, -v37
v_fma_f32 v47, v112, v46, -v45
v_fma_f32 v55, v112, v54, -v53
v_fma_f32 v63, v112, v62, -v61
v_fma_f32 v126, v112, v125, -v124
v_cvt_pk_bf16_f32 v128, v32, v33
v_cvt_pk_bf16_f32 v129, v34, v35
v_cvt_pk_bf16_f32 v130, v36, v37
v_cvt_pk_bf16_f32 v131, v38, v39
v_cvt_pk_bf16_f32 v132, v40, v41
v_cvt_pk_bf16_f32 v133, v42, v43
v_cvt_pk_bf16_f32 v134, v44, v45
v_cvt_pk_bf16_f32 v135, v46, v47
v_cvt_pk_bf16_f32 v136, v48, v49
v_cvt_pk_bf16_f32 v137, v50, v51
v_cvt_pk_bf16_f32 v138, v52, v53
v_cvt_pk_bf16_f32 v139, v54, v55
v_cvt_pk_bf16_f32 v140, v56, v57
v_cvt_pk_bf16_f32 v141, v58, v59
v_cvt_pk_bf16_f32 v142, v60, v61
v_cvt_pk_bf16_f32 v143, v62, v63
v_cvt_pk_bf16_f32 v144, v119, v120
v_cvt_pk_bf16_f32 v145, v121, v122
v_cvt_pk_bf16_f32 v146, v123, v124
v_cvt_pk_bf16_f32 v147, v125, v126
s_add_u32 s3, s20, 1
s_and_b32 s3, s3, 3
s_mul_i32 s3, s3, 80
v_cvt_f32_u32 v6, s3
v_fma_f32 v6, v6, v109, v110
v_mov_b32 v114, v6
s_mov_b32 s6, 0x41800000
v_fma_f32 v115, s6, v109, v6
s_mov_b32 s6, 0x42000000
v_fma_f32 v116, s6, v109, v6
s_mov_b32 s6, 0x42400000
v_fma_f32 v117, s6, v109, v6
s_mov_b32 s6, 0x42800000
v_fma_f32 v118, s6, v109, v6
v_fma_f32 v114, v114, s5, v113
v_fma_f32 v115, v115, s5, v113
v_fma_f32 v116, v116, s5, v113
v_fma_f32 v117, v117, s5, v113
v_fma_f32 v118, v118, s5, v113
v_fract_f32 v114, v114
v_fract_f32 v115, v115
v_fract_f32 v116, v116
v_fract_f32 v117, v117
v_fract_f32 v118, v118
v_cos_f32 v32, v114
v_cos_f32 v40, v115
v_cos_f32 v48, v116
v_cos_f32 v56, v117
v_cos_f32 v119, v118
v_add_f32 v114, v114, v111
v_add_f32 v115, v115, v111
v_add_f32 v116, v116, v111
v_add_f32 v117, v117, v111
v_add_f32 v118, v118, v111
v_cos_f32 v33, v114
v_cos_f32 v41, v115
v_cos_f32 v49, v116
v_cos_f32 v57, v117
v_cos_f32 v120, v118
v_fma_f32 v34, v112, v33, -v32
v_fma_f32 v42, v112, v41, -v40
v_fma_f32 v50, v112, v49, -v48
v_fma_f32 v58, v112, v57, -v56
v_fma_f32 v121, v112, v120, -v119
v_fma_f32 v35, v112, v34, -v33
v_fma_f32 v43, v112, v42, -v41
v_fma_f32 v51, v112, v50, -v49
v_fma_f32 v59, v112, v58, -v57
v_fma_f32 v122, v112, v121, -v120
v_fma_f32 v36, v112, v35, -v34
v_fma_f32 v44, v112, v43, -v42
v_fma_f32 v52, v112, v51, -v50
v_fma_f32 v60, v112, v59, -v58
v_fma_f32 v123, v112, v122, -v121
v_fma_f32 v37, v112, v36, -v35
v_fma_f32 v45, v112, v44, -v43
v_fma_f32 v53, v112, v52, -v51
v_fma_f32 v61, v112, v60, -v59
v_fma_f32 v124, v112, v123, -v122
v_fma_f32 v38, v112, v37, -v36
v_fma_f32 v46, v112, v45, -v44
v_fma_f32 v54, v112, v53, -v52
v_fma_f32 v62, v112, v61, -v60
v_fma_f32 v125, v112, v124, -v123
v_fma_f32 v39, v112, v38, -v37
v_fma_f32 v47, v112, v46, -v45
v_fma_f32 v55, v112, v54, -v53
v_fma_f32 v63, v112, v62, -v61
v_fma_f32 v126, v112, v125, -v124
v_cvt_pk_bf16_f32 v148, v32, v33
v_cvt_pk_bf16_f32 v149, v34, v35
v_cvt_pk_bf16_f32 v150, v36, v37
v_cvt_pk_bf16_f32 v151, v38, v39
v_cvt_pk_bf16_f32 v152, v40, v41
v_cvt_pk_bf16_f32 v153, v42, v43
v_cvt_pk_bf16_f32 v154, v44, v45
v_cvt_pk_bf16_f32 v155, v46, v47
v_cvt_pk_bf16_f32 v156, v48, v49
v_cvt_pk_bf16_f32 v157, v50, v51
v_cvt_pk_bf16_f32 v158, v52, v53
v_cvt_pk_bf16_f32 v159, v54, v55
v_cvt_pk_bf16_f32 v160, v56, v57
v_cvt_pk_bf16_f32 v161, v58, v59
v_cvt_pk_bf16_f32 v162, v60, v61
v_cvt_pk_bf16_f32 v163, v62, v63
v_cvt_pk_bf16_f32 v164, v119, v120
v_cvt_pk_bf16_f32 v165, v121, v122
v_cvt_pk_bf16_f32 v166, v123, v124
v_cvt_pk_bf16_f32 v167, v125, v126
s_add_u32 s3, s20, 2
s_and_b32 s3, s3, 3
s_mul_i32 s3, s3, 80
v_cvt_f32_u32 v6, s3
v_fma_f32 v6, v6, v109, v110
v_mov_b32 v114, v6
s_mov_b32 s6, 0x41800000
v_fma_f32 v115, s6, v109, v6
s_mov_b32 s6, 0x42000000
v_fma_f32 v116, s6, v109, v6
s_mov_b32 s6, 0x42400000
v_fma_f32 v117, s6, v109, v6
s_mov_b32 s6, 0x42800000
v_fma_f32 v118, s6, v109, v6
v_fma_f32 v114, v114, s5, v113
v_fma_f32 v115, v115, s5, v113
v_fma_f32 v116, v116, s5, v113
v_fma_f32 v117, v117, s5, v113
v_fma_f32 v118, v118, s5, v113
v_fract_f32 v114, v114
v_fract_f32 v115, v115
v_fract_f32 v116, v116
v_fract_f32 v117, v117
v_fract_f32 v118, v118
v_cos_f32 v32, v114
v_cos_f32 v40, v115
v_cos_f32 v48, v116
v_cos_f32 v56, v117
v_cos_f32 v119, v118
v_add_f32 v114, v114, v111
v_add_f32 v115, v115, v111
v_add_f32 v116, v116, v111
v_add_f32 v117, v117, v111
v_add_f32 v118, v118, v111
v_cos_f32 v33, v114
v_cos_f32 v41, v115
v_cos_f32 v49, v116
v_cos_f32 v57, v117
v_cos_f32 v120, v118
v_fma_f32 v34, v112, v33, -v32
v_fma_f32 v42, v112, v41, -v40
v_fma_f32 v50, v112, v49, -v48
v_fma_f32 v58, v112, v57, -v56
v_fma_f32 v121, v112, v120, -v119
v_fma_f32 v35, v112, v34, -v33
v_fma_f32 v43, v112, v42, -v41
v_fma_f32 v51, v112, v50, -v49
v_fma_f32 v59, v112, v58, -v57
v_fma_f32 v122, v112, v121, -v120
v_fma_f32 v36, v112, v35, -v34
v_fma_f32 v44, v112, v43, -v42
v_fma_f32 v52, v112, v51, -v50
v_fma_f32 v60, v112, v59, -v58
v_fma_f32 v123, v112, v122, -v121
v_fma_f32 v37, v112, v36, -v35
v_fma_f32 v45, v112, v44, -v43
v_fma_f32 v53, v112, v52, -v51
v_fma_f32 v61, v112, v60, -v59
v_fma_f32 v124, v112, v123, -v122
v_fma_f32 v38, v112, v37, -v36
v_fma_f32 v46, v112, v45, -v44
v_fma_f32 v54, v112, v53, -v52
v_fma_f32 v62, v112, v61, -v60
v_fma_f32 v125, v112, v124, -v123
v_fma_f32 v39, v112, v38, -v37
v_fma_f32 v47, v112, v46, -v45
v_fma_f32 v55, v112, v54, -v53
v_fma_f32 v63, v112, v62, -v61
v_fma_f32 v126, v112, v125, -v124
v_cvt_pk_bf16_f32 v168, v32, v33
v_cvt_pk_bf16_f32 v169, v34, v35
v_cvt_pk_bf16_f32 v170, v36, v37
v_cvt_pk_bf16_f32 v171, v38, v39
v_cvt_pk_bf16_f32 v172, v40, v41
v_cvt_pk_bf16_f32 v173, v42, v43
v_cvt_pk_bf16_f32 v174, v44, v45
v_cvt_pk_bf16_f32 v175, v46, v47
v_cvt_pk_bf16_f32 v176, v48, v49
v_cvt_pk_bf16_f32 v177, v50, v51
v_cvt_pk_bf16_f32 v178, v52, v53
v_cvt_pk_bf16_f32 v179, v54, v55
v_cvt_pk_bf16_f32 v180, v56, v57
v_cvt_pk_bf16_f32 v181, v58, v59
v_cvt_pk_bf16_f32 v182, v60, v61
v_cvt_pk_bf16_f32 v183, v62, v63
v_cvt_pk_bf16_f32 v184, v119, v120
v_cvt_pk_bf16_f32 v185, v121, v122
v_cvt_pk_bf16_f32 v186, v123, v124
v_cvt_pk_bf16_f32 v187, v125, v126
s_add_u32 s3, s20, 3
s_and_b32 s3, s3, 3
s_mul_i32 s3, s3, 80
v_cvt_f32_u32 v6, s3
v_fma_f32 v6, v6, v109, v110
v_mov_b32 v114, v6
s_mov_b32 s6, 0x41800000
v_fma_f32 v115, s6, v109, v6
s_mov_b32 s6, 0x42000000
v_fma_f32 v116, s6, v109, v6
s_mov_b32 s6, 0x42400000
v_fma_f32 v117, s6, v109, v6
s_mov_b32 s6, 0x42800000
v_fma_f32 v118, s6, v109, v6
v_fma_f32 v114, v114, s5, v113
v_fma_f32 v115, v115, s5, v113
v_fma_f32 v116, v116, s5, v113
v_fma_f32 v117, v117, s5, v113
v_fma_f32 v118, v118, s5, v113
v_fract_f32 v114, v114
v_fract_f32 v115, v115
v_fract_f32 v116, v116
v_fract_f32 v117, v117
v_fract_f32 v118, v118
v_cos_f32 v32, v114
v_cos_f32 v40, v115
v_cos_f32 v48, v116
v_cos_f32 v56, v117
v_cos_f32 v119, v118
v_add_f32 v114, v114, v111
v_add_f32 v115, v115, v111
v_add_f32 v116, v116, v111
v_add_f32 v117, v117, v111
v_add_f32 v118, v118, v111
v_cos_f32 v33, v114
v_cos_f32 v41, v115
v_cos_f32 v49, v116
v_cos_f32 v57, v117
v_cos_f32 v120, v118
v_fma_f32 v34, v112, v33, -v32
v_fma_f32 v42, v112, v41, -v40
v_fma_f32 v50, v112, v49, -v48
v_fma_f32 v58, v112, v57, -v56
v_fma_f32 v121, v112, v120, -v119
v_fma_f32 v35, v112, v34, -v33
v_fma_f32 v43, v112, v42, -v41
v_fma_f32 v51, v112, v50, -v49
v_fma_f32 v59, v112, v58, -v57
v_fma_f32 v122, v112, v121, -v120
v_fma_f32 v36, v112, v35, -v34
v_fma_f32 v44, v112, v43, -v42
v_fma_f32 v52, v112, v51, -v50
v_fma_f32 v60, v112, v59, -v58
v_fma_f32 v123, v112, v122, -v121
v_fma_f32 v37, v112, v36, -v35
v_fma_f32 v45, v112, v44, -v43
v_fma_f32 v53, v112, v52, -v51
v_fma_f32 v61, v112, v60, -v59
v_fma_f32 v124, v112, v123, -v122
v_fma_f32 v38, v112, v37, -v36
v_fma_f32 v46, v112, v45, -v44
v_fma_f32 v54, v112, v53, -v52
v_fma_f32 v62, v112, v61, -v60
v_fma_f32 v125, v112, v124, -v123
v_fma_f32 v39, v112, v38, -v37
v_fma_f32 v47, v112, v46, -v45
v_fma_f32 v55, v112, v54, -v53
v_fma_f32 v63, v112, v62, -v61
v_fma_f32 v126, v112, v125, -v124
v_cvt_pk_bf16_f32 v188, v32, v33
v_cvt_pk_bf16_f32 v189, v34, v35
v_cvt_pk_bf16_f32 v190, v36, v37
v_cvt_pk_bf16_f32 v191, v38, v39
v_cvt_pk_bf16_f32 v192, v40, v41
v_cvt_pk_bf16_f32 v193, v42, v43
v_cvt_pk_bf16_f32 v194, v44, v45
v_cvt_pk_bf16_f32 v195, v46, v47
v_cvt_pk_bf16_f32 v196, v48, v49
v_cvt_pk_bf16_f32 v197, v50, v51
v_cvt_pk_bf16_f32 v198, v52, v53
v_cvt_pk_bf16_f32 v199, v54, v55
v_cvt_pk_bf16_f32 v200, v56, v57
v_cvt_pk_bf16_f32 v201, v58, v59
v_cvt_pk_bf16_f32 v202, v60, v61
v_cvt_pk_bf16_f32 v203, v62, v63
v_cvt_pk_bf16_f32 v204, v119, v120
v_cvt_pk_bf16_f32 v205, v121, v122
v_cvt_pk_bf16_f32 v206, v123, v124
v_cvt_pk_bf16_f32 v207, v125, v126
s_mul_i32 s3, s22, 5
s_add_u32 s4, s3, 4
s_lshl_b32 s4, s4, 4
v_and_b32 v4, 15, v2
v_add_u32 v4, s4, v4
v_cmp_eq_u32 vcc, 0, v4
v_mov_b32 v5, 320
s_nop 0
v_cndmask_b32 v4, v4, v5, vcc
v_cvt_f32_u32 v109, v4
v_cvt_f32_u32 v5, v3
v_mul_f32 v5, 0x41000000, v5
v_mul_f32 v110, v5, v109
v_mul_f32 v111, 0x3acccccd, v109
v_cos_f32 v112, v111
v_cmp_lt_u32 vcc, 15, v2
v_mov_b32 v5, 0x3e800000
s_nop 0
v_cndmask_b32 v113, 0, v5, vcc
v_add_f32 v112, v112, v112
s_mov_b32 s5, 0x3acccccd
s_add_u32 s3, s20, 0
s_and_b32 s3, s3, 3
s_mul_i32 s3, s3, 80
v_cvt_f32_u32 v6, s3
v_fma_f32 v6, v6, v109, v110
v_mov_b32 v114, v6
s_mov_b32 s6, 0x41800000
v_fma_f32 v115, s6, v109, v6
s_mov_b32 s6, 0x42000000
v_fma_f32 v116, s6, v109, v6
s_mov_b32 s6, 0x42400000
v_fma_f32 v117, s6, v109, v6
s_mov_b32 s6, 0x42800000
v_fma_f32 v118, s6, v109, v6
v_fma_f32 v114, v114, s5, v113
v_fma_f32 v115, v115, s5, v113
v_fma_f32 v116, v116, s5, v113
v_fma_f32 v117, v117, s5, v113
v_fma_f32 v118, v118, s5, v113
v_fract_f32 v114, v114
v_fract_f32 v115, v115
v_fract_f32 v116, v116
v_fract_f32 v117, v117
v_fract_f32 v118, v118
v_cos_f32 v32, v114
v_cos_f32 v40, v115
v_cos_f32 v48, v116
v_cos_f32 v56, v117
v_cos_f32 v119, v118
v_add_f32 v114, v114, v111
v_add_f32 v115, v115, v111
v_add_f32 v116, v116, v111
v_add_f32 v117, v117, v111
v_add_f32 v118, v118, v111
v_cos_f32 v33, v114
v_cos_f32 v41, v115
v_cos_f32 v49, v116
v_cos_f32 v57, v117
v_cos_f32 v120, v118
v_fma_f32 v34, v112, v33, -v32
v_fma_f32 v42, v112, v41, -v40
v_fma_f32 v50, v112, v49, -v48
v_fma_f32 v58, v112, v57, -v56
v_fma_f32 v121, v112, v120, -v119
v_fma_f32 v35, v112, v34, -v33
v_fma_f32 v43, v112, v42, -v41
v_fma_f32 v51, v112, v50, -v49
v_fma_f32 v59, v112, v58, -v57
v_fma_f32 v122, v112, v121, -v120
v_fma_f32 v36, v112, v35, -v34
v_fma_f32 v44, v112, v43, -v42
v_fma_f32 v52, v112, v51, -v50
v_fma_f32 v60, v112, v59, -v58
v_fma_f32 v123, v112, v122, -v121
v_fma_f32 v37, v112, v36, -v35
v_fma_f32 v45, v112, v44, -v43
v_fma_f32 v53, v112, v52, -v51
v_fma_f32 v61, v112, v60, -v59
v_fma_f32 v124, v112, v123, -v122
v_fma_f32 v38, v112, v37, -v36
v_fma_f32 v46, v112, v45, -v44
v_fma_f32 v54, v112, v53, -v52
v_fma_f32 v62, v112, v61, -v60
v_fma_f32 v125, v112, v124, -v123
v_fma_f32 v39, v112, v38, -v37
v_fma_f32 v47, v112, v46, -v45
v_fma_f32 v55, v112, v54, -v53
v_fma_f32 v63, v112, v62, -v61
v_fma_f32 v126, v112, v125, -v124
v_cvt_pk_bf16_f32 v208, v32, v33
v_cvt_pk_bf16_f32 v209, v34, v35
v_cvt_pk_bf16_f32 v210, v36, v37
v_cvt_pk_bf16_f32 v211, v38, v39
v_cvt_pk_bf16_f32 v212, v40, v41
v_cvt_pk_bf16_f32 v213, v42, v43
v_cvt_pk_bf16_f32 v214, v44, v45
v_cvt_pk_bf16_f32 v215, v46, v47
v_cvt_pk_bf16_f32 v216, v48, v49
v_cvt_pk_bf16_f32 v217, v50, v51
v_cvt_pk_bf16_f32 v218, v52, v53
v_cvt_pk_bf16_f32 v219, v54, v55
v_cvt_pk_bf16_f32 v220, v56, v57
v_cvt_pk_bf16_f32 v221, v58, v59
v_cvt_pk_bf16_f32 v222, v60, v61
v_cvt_pk_bf16_f32 v223, v62, v63
v_cvt_pk_bf16_f32 v224, v119, v120
v_cvt_pk_bf16_f32 v225, v121, v122
v_cvt_pk_bf16_f32 v226, v123, v124
v_cvt_pk_bf16_f32 v227, v125, v126
v_mov_b32 v254, 0
v_mov_b32 v255, 0
v_mov_b32 v4, 0x3f803f80
v_dot2c_f32_bf16 v254, v128, v4
v_dot2c_f32_bf16 v254, v129, v4
v_dot2c_f32_bf16 v254, v130, v4
v_dot2c_f32_bf16 v254, v131, v4
v_dot2c_f32_bf16 v254, v132, v4
v_dot2c_f32_bf16 v254, v133, v4
v_dot2c_f32_bf16 v254, v134, v4
v_dot2c_f32_bf16 v254, v135, v4
v_dot2c_f32_bf16 v254, v136, v4
v_dot2c_f32_bf16 v254, v137, v4
v_dot2c_f32_bf16 v254, v138, v4
v_dot2c_f32_bf16 v254, v139, v4
v_dot2c_f32_bf16 v254, v140, v4
v_dot2c_f32_bf16 v254, v141, v4
v_dot2c_f32_bf16 v254, v142, v4
v_dot2c_f32_bf16 v254, v143, v4
v_dot2c_f32_bf16 v254, v144, v4
v_dot2c_f32_bf16 v254, v145, v4
v_dot2c_f32_bf16 v254, v146, v4
v_dot2c_f32_bf16 v254, v147, v4
v_dot2c_f32_bf16 v254, v148, v4
v_dot2c_f32_bf16 v254, v149, v4
v_dot2c_f32_bf16 v254, v150, v4
v_dot2c_f32_bf16 v254, v151, v4
v_dot2c_f32_bf16 v254, v152, v4
v_dot2c_f32_bf16 v254, v153, v4
v_dot2c_f32_bf16 v254, v154, v4
v_dot2c_f32_bf16 v254, v155, v4
v_dot2c_f32_bf16 v254, v156, v4
v_dot2c_f32_bf16 v254, v157, v4
v_dot2c_f32_bf16 v254, v158, v4
v_dot2c_f32_bf16 v254, v159, v4
v_dot2c_f32_bf16 v254, v160, v4
v_dot2c_f32_bf16 v254, v161, v4
v_dot2c_f32_bf16 v254, v162, v4
v_dot2c_f32_bf16 v254, v163, v4
v_dot2c_f32_bf16 v254, v164, v4
v_dot2c_f32_bf16 v254, v165, v4
v_dot2c_f32_bf16 v254, v166, v4
v_dot2c_f32_bf16 v254, v167, v4
v_dot2c_f32_bf16 v254, v168, v4
v_dot2c_f32_bf16 v254, v169, v4
v_dot2c_f32_bf16 v254, v170, v4
v_dot2c_f32_bf16 v254, v171, v4
v_dot2c_f32_bf16 v254, v172, v4
v_dot2c_f32_bf16 v254, v173, v4
v_dot2c_f32_bf16 v254, v174, v4
v_dot2c_f32_bf16 v254, v175, v4
v_dot2c_f32_bf16 v254, v176, v4
v_dot2c_f32_bf16 v254, v177, v4
v_dot2c_f32_bf16 v254, v178, v4
v_dot2c_f32_bf16 v254, v179, v4
v_dot2c_f32_bf16 v254, v180, v4
v_dot2c_f32_bf16 v254, v181, v4
v_dot2c_f32_bf16 v254, v182, v4
v_dot2c_f32_bf16 v254, v183, v4
v_dot2c_f32_bf16 v254, v184, v4
v_dot2c_f32_bf16 v254, v185, v4
v_dot2c_f32_bf16 v254, v186, v4
v_dot2c_f32_bf16 v254, v187, v4
v_dot2c_f32_bf16 v254, v188, v4
v_dot2c_f32_bf16 v254, v189, v4
v_dot2c_f32_bf16 v254, v190, v4
v_dot2c_f32_bf16 v254, v191, v4
v_dot2c_f32_bf16 v254, v192, v4
v_dot2c_f32_bf16 v254, v193, v4
v_dot2c_f32_bf16 v254, v194, v4
v_dot2c_f32_bf16 v254, v195, v4
v_dot2c_f32_bf16 v254, v196, v4
v_dot2c_f32_bf16 v254, v197, v4
v_dot2c_f32_bf16 v254, v198, v4
v_dot2c_f32_bf16 v254, v199, v4
v_dot2c_f32_bf16 v254, v200, v4
v_dot2c_f32_bf16 v254, v201, v4
v_dot2c_f32_bf16 v254, v202, v4
v_dot2c_f32_bf16 v254, v203, v4
v_dot2c_f32_bf16 v254, v204, v4
v_dot2c_f32_bf16 v254, v205, v4
v_dot2c_f32_bf16 v254, v206, v4
v_dot2c_f32_bf16 v254, v207, v4
v_dot2c_f32_bf16 v255, v208, v4
v_dot2c_f32_bf16 v255, v209, v4
v_dot2c_f32_bf16 v255, v210, v4
v_dot2c_f32_bf16 v255, v211, v4
v_dot2c_f32_bf16 v255, v212, v4
v_dot2c_f32_bf16 v255, v213, v4
v_dot2c_f32_bf16 v255, v214, v4
v_dot2c_f32_bf16 v255, v215, v4
v_dot2c_f32_bf16 v255, v216, v4
v_dot2c_f32_bf16 v255, v217, v4
v_dot2c_f32_bf16 v255, v218, v4
v_dot2c_f32_bf16 v255, v219, v4
v_dot2c_f32_bf16 v255, v220, v4
v_dot2c_f32_bf16 v255, v221, v4
v_dot2c_f32_bf16 v255, v222, v4
v_dot2c_f32_bf16 v255, v223, v4
v_dot2c_f32_bf16 v255, v224, v4
v_dot2c_f32_bf16 v255, v225, v4
v_dot2c_f32_bf16 v255, v226, v4
v_dot2c_f32_bf16 v255, v227, v4
s_nop 2
v_and_b32 v5, 0x31, v0
v_cmp_eq_u32 vcc, 1, v5
v_mov_b32 v6, -2.0
v_mov_b32 v7, -0.5
v_cndmask_b32 v6, 0, v6, vcc
v_cndmask_b32 v7, 0, v7, vcc
v_fma_f32 v254, 2.0, v254, v6
v_fma_f32 v255, 2.0, v255, v7
v_mov_b32 v5, v254
s_nop 1
v_permlane32_swap_b32 v5, v254
v_add_f32 v254, v254, v5
v_mov_b32 v5, v255
s_nop 1
v_permlane32_swap_b32 v5, v255
v_add_f32 v255, v255, v5
v_cmp_gt_u32 vcc, 16, v2
s_nop 1
v_cndmask_b32 v254, 0, v254, vcc
v_cndmask_b32 v255, 0, v255, vcc
v_cmp_eq_u32 vcc, 0, v3
v_sub_f32 v4, 0, v254
s_nop 0
v_cndmask_b32 v4, 0, v4, vcc
v_and_b32 v5, 0xffff0000, v4
v_sub_f32 v6, v4, v5
v_cvt_pk_bf16_f32 v6, v6, v6
v_or_b32 v228, v228, v5
v_lshrrev_b32 v5, 16, v5
v_and_b32 v6, 0xffff0000, v6
v_or_b32 v229, v5, v6
v_sub_f32 v4, 0, v255
v_cndmask_b32 v4, 0, v4, vcc
v_and_b32 v5, 0xffff0000, v4
v_sub_f32 v6, v4, v5
v_cvt_pk_bf16_f32 v6, v6, v6
v_or_b32 v232, v232, v5
v_lshrrev_b32 v5, 16, v5
v_and_b32 v6, 0xffff0000, v6
v_or_b32 v233, v5, v6
v_mov_b32 v11, v251
v_mov_b32 v12, v252
s_waitcnt vmcnt(0)
s_mov_b32 s3, 0x07060100
v_perm_b32 v112, v87, v104, s3
v_perm_b32 v113, v86, v87, s3
v_perm_b32 v114, v85, v86, s3
v_perm_b32 v115, v84, v85, s3
v_perm_b32 v116, v91, v105, s3
v_perm_b32 v117, v90, v91, s3
v_perm_b32 v118, v89, v90, s3
v_perm_b32 v119, v88, v89, s3
v_perm_b32 v120, v95, v106, s3
v_perm_b32 v121, v94, v95, s3
v_perm_b32 v122, v93, v94, s3
v_perm_b32 v123, v92, v93, s3
v_perm_b32 v124, v99, v107, s3
v_perm_b32 v125, v98, v99, s3
v_perm_b32 v126, v97, v98, s3
v_perm_b32 v127, v96, v97, s3
v_perm_b32 v108, v103, v108, s3
v_perm_b32 v109, v102, v103, s3
v_perm_b32 v110, v101, v102, s3
v_perm_b32 v111, v100, v101, s3
v_mul_u32_u24 v4, 1296, v11
v_lshl_add_u32 v5, v12, 4, v4
v_lshlrev_b32 v6, 4, v12
v_sub_u32 v6, v4, v6
v_add_u32 v6, 752, v6
ds_write_b128 v5, v[64:67] offset:0
ds_write_b128 v5, v[68:71] offset:128
ds_write_b128 v5, v[72:75] offset:256
ds_write_b128 v5, v[76:79] offset:384
ds_write_b128 v5, v[80:83] offset:512
ds_write_b128 v6, v[112:115] offset:512
ds_write_b128 v6, v[116:119] offset:384
ds_write_b128 v6, v[120:123] offset:256
ds_write_b128 v6, v[124:127] offset:128
ds_write_b128 v6, v[108:111] offset:0
v_mov_b32 v248, 0
v_mov_b32 v249, 0
v_mov_b32 v250, 0x3f803f80
v_dot2c_f32_bf16 v248, v64, v250
v_dot2c_f32_bf16 v249, v64, v64
v_dot2c_f32_bf16 v248, v65, v250
v_dot2c_f32_bf16 v249, v65, v65
v_dot2c_f32_bf16 v248, v66, v250
v_dot2c_f32_bf16 v249, v66, v66
v_dot2c_f32_bf16 v248, v67, v250
v_dot2c_f32_bf16 v249, v67, v67
v_dot2c_f32_bf16 v248, v68, v250
v_dot2c_f32_bf16 v249, v68, v68
v_dot2c_f32_bf16 v248, v69, v250
v_dot2c_f32_bf16 v249, v69, v69
v_dot2c_f32_bf16 v248, v70, v250
v_dot2c_f32_bf16 v249, v70, v70
v_dot2c_f32_bf16 v248, v71, v250
v_dot2c_f32_bf16 v249, v71, v71
v_dot2c_f32_bf16 v248, v72, v250
v_dot2c_f32_bf16 v249, v72, v72
v_dot2c_f32_bf16 v248, v73, v250
v_dot2c_f32_bf16 v249, v73, v73
v_dot2c_f32_bf16 v248, v74, v250
v_dot2c_f32_bf16 v249, v74, v74
v_dot2c_f32_bf16 v248, v75, v250
v_dot2c_f32_bf16 v249, v75, v75
v_dot2c_f32_bf16 v248, v76, v250
v_dot2c_f32_bf16 v249, v76, v76
v_dot2c_f32_bf16 v248, v77, v250
v_dot2c_f32_bf16 v249, v77, v77
v_dot2c_f32_bf16 v248, v78, v250
v_dot2c_f32_bf16 v249, v78, v78
v_dot2c_f32_bf16 v248, v79, v250
v_dot2c_f32_bf16 v249, v79, v79
v_dot2c_f32_bf16 v248, v80, v250
v_dot2c_f32_bf16 v249, v80, v80
v_dot2c_f32_bf16 v248, v81, v250
v_dot2c_f32_bf16 v249, v81, v81
v_dot2c_f32_bf16 v248, v82, v250
v_dot2c_f32_bf16 v249, v82, v82
v_dot2c_f32_bf16 v248, v83, v250
v_dot2c_f32_bf16 v249, v83, v83
v_dot2c_f32_bf16 v248, v112, v250
v_dot2c_f32_bf16 v249, v112, v112
v_dot2c_f32_bf16 v248, v113, v250
v_dot2c_f32_bf16 v249, v113, v113
v_dot2c_f32_bf16 v248, v114, v250
v_dot2c_f32_bf16 v249, v114, v114
v_dot2c_f32_bf16 v248, v115, v250
v_dot2c_f32_bf16 v249, v115, v115
v_dot2c_f32_bf16 v248, v116, v250
v_dot2c_f32_bf16 v249, v116, v116
v_dot2c_f32_bf16 v248, v117, v250
v_dot2c_f32_bf16 v249, v117, v117
v_dot2c_f32_bf16 v248, v118, v250
v_dot2c_f32_bf16 v249, v118, v118
v_dot2c_f32_bf16 v248, v119, v250
v_dot2c_f32_bf16 v249, v119, v119
v_dot2c_f32_bf16 v248, v120, v250
v_dot2c_f32_bf16 v249, v120, v120
v_dot2c_f32_bf16 v248, v121, v250
v_dot2c_f32_bf16 v249, v121, v121
v_dot2c_f32_bf16 v248, v122, v250
v_dot2c_f32_bf16 v249, v122, v122
v_dot2c_f32_bf16 v248, v123, v250
v_dot2c_f32_bf16 v249, v123, v123
v_dot2c_f32_bf16 v248, v124, v250
v_dot2c_f32_bf16 v249, v124, v124
v_dot2c_f32_bf16 v248, v125, v250
v_dot2c_f32_bf16 v249, v125, v125
v_dot2c_f32_bf16 v248, v126, v250
v_dot2c_f32_bf16 v249, v126, v126
v_dot2c_f32_bf16 v248, v127, v250
v_dot2c_f32_bf16 v249, v127, v127
v_dot2c_f32_bf16 v248, v108, v250
v_dot2c_f32_bf16 v249, v108, v108
v_dot2c_f32_bf16 v248, v109, v250
v_dot2c_f32_bf16 v249, v109, v109
v_dot2c_f32_bf16 v248, v110, v250
v_dot2c_f32_bf16 v249, v110, v110
v_dot2c_f32_bf16 v248, v111, v250
v_dot2c_f32_bf16 v249, v111, v111
s_nop 1
v_add_f32_dpp v248, v248, v248 quad_perm:[1,0,3,2] row_mask:0xf bank_mask:0xf
v_add_f32_dpp v249, v249, v249 quad_perm:[1,0,3,2] row_mask:0xf bank_mask:0xf
s_nop 0
v_add_f32_dpp v248, v248, v248 quad_perm:[2,3,0,1] row_mask:0xf bank_mask:0xf
v_add_f32_dpp v249, v249, v249 quad_perm:[2,3,0,1] row_mask:0xf bank_mask:0xf
s_nop 0
v_add_f32_dpp v248, v248, v248 row_half_mirror row_mask:0xf bank_mask:0xf
v_add_f32_dpp v249, v249, v249 row_half_mirror row_mask:0xf bank_mask:0xf
v_mul_f32 v248, 0x3acccccd, v248
v_mul_f32 v249, 0x3acccccd, v249
v_fma_f32 v249, -v248, v248, v249
v_max_f32 v249, 0, v249
v_add_f32 v249, 0x3727c5ac, v249
v_rsq_f32 v249, v249
v_lshlrev_b32 v4, 2, v11
ds_write_b32 v4, v249 offset:41472
ds_write_b32 v4, v248 offset:41984
s_waitcnt lgkmcnt(0)
s_barrier
v_lshlrev_b32 v4, 2, v2
ds_read_b32 v5, v4 offset:41984
s_waitcnt lgkmcnt(0)
v_and_b32 v245, 0xffff0000, v5
v_sub_f32 v4, v5, v245
v_cvt_pk_bf16_f32 v4, v4, v4
v_and_b32 v4, 0xffff, v4
v_or_b32 v246, v4, v245
s_cmp_ge_u32 s21, 25
s_cbranch_scc1 l1_kernel_norf
s_lshl_b32 s3, s22, 2
s_add_u32 s3, s3, s20
s_mul_i32 s3, s3, 25600
s_lshl_b32 s4, s21, 10
s_add_u32 s3, s3, s4
s_add_u32 s3, s3, 45088768
s_cmp_lg_u32 s21, 0
s_cbranch_scc1 l1_kernel_rf0
buffer_store_dwordx4 v[128:131], v1, s[8:11], s3 offen sc1
l1_kernel_rf0:
s_cmp_lg_u32 s21, 1
s_cbranch_scc1 l1_kernel_rf1
buffer_store_dwordx4 v[132:135], v1, s[8:11], s3 offen sc1
l1_kernel_rf1:
s_cmp_lg_u32 s21, 2
s_cbranch_scc1 l1_kernel_rf2
buffer_store_dwordx4 v[136:139], v1, s[8:11], s3 offen sc1
l1_kernel_rf2:
s_cmp_lg_u32 s21, 3
s_cbranch_scc1 l1_kernel_rf3
buffer_store_dwordx4 v[140:143], v1, s[8:11], s3 offen sc1
l1_kernel_rf3:
s_cmp_lg_u32 s21, 4
s_cbranch_scc1 l1_kernel_rf4
buffer_store_dwordx4 v[144:147], v1, s[8:11], s3 offen sc1
l1_kernel_rf4:
s_cmp_lg_u32 s21, 5
s_cbranch_scc1 l1_kernel_rf5
buffer_store_dwordx4 v[148:151], v1, s[8:11], s3 offen sc1
l1_kernel_rf5:
s_cmp_lg_u32 s21, 6
s_cbranch_scc1 l1_kernel_rf6
buffer_store_dwordx4 v[152:155], v1, s[8:11], s3 offen sc1
l1_kernel_rf6:
s_cmp_lg_u32 s21, 7
s_cbranch_scc1 l1_kernel_rf7
buffer_store_dwordx4 v[156:159], v1, s[8:11], s3 offen sc1
l1_kernel_rf7:
s_cmp_lg_u32 s21, 8
s_cbranch_scc1 l1_kernel_rf8
buffer_store_dwordx4 v[160:163], v1, s[8:11], s3 offen sc1
l1_kernel_rf8:
s_cmp_lg_u32 s21, 9
s_cbranch_scc1 l1_kernel_rf9
buffer_store_dwordx4 v[164:167], v1, s[8:11], s3 offen sc1
l1_kernel_rf9:
s_cmp_lg_u32 s21, 10
s_cbranch_scc1 l1_kernel_rf10
buffer_store_dwordx4 v[168:171], v1, s[8:11], s3 offen sc1
l1_kernel_rf10:
s_cmp_lg_u32 s21, 11
s_cbranch_scc1 l1_kernel_rf11
buffer_store_dwordx4 v[172:175], v1, s[8:11], s3 offen sc1
l1_kernel_rf11:
s_cmp_lg_u32 s21, 12
s_cbranch_scc1 l1_kernel_rf12
buffer_store_dwordx4 v[176:179], v1, s[8:11], s3 offen sc1
l1_kernel_rf12:
s_cmp_lg_u32 s21, 13
s_cbranch_scc1 l1_kernel_rf13
buffer_store_dwordx4 v[180:183], v1, s[8:11], s3 offen sc1
l1_kernel_rf13:
s_cmp_lg_u32 s21, 14
s_cbranch_scc1 l1_kernel_rf14
buffer_store_dwordx4 v[184:187], v1, s[8:11], s3 offen sc1
l1_kernel_rf14:
s_cmp_lg_u32 s21, 15
s_cbranch_scc1 l1_kernel_rf15
buffer_store_dwordx4 v[188:191], v1, s[8:11], s3 offen sc1
l1_kernel_rf15:
s_cmp_lg_u32 s21, 16
s_cbranch_scc1 l1_kernel_rf16
buffer_store_dwordx4 v[192:195], v1, s[8:11], s3 offen sc1
l1_kernel_rf16:
s_cmp_lg_u32 s21, 17
s_cbranch_scc1 l1_kernel_rf17
buffer_store_dwordx4 v[196:199], v1, s[8:11], s3 offen sc1
l1_kernel_rf17:
s_cmp_lg_u32 s21, 18
s_cbranch_scc1 l1_kernel_rf18
buffer_store_dwordx4 v[200:203], v1, s[8:11], s3 offen sc1
l1_kernel_rf18:
s_cmp_lg_u32 s21, 19
s_cbranch_scc1 l1_kernel_rf19
buffer_store_dwordx4 v[204:207], v1, s[8:11], s3 offen sc1
l1_kernel_rf19:
s_cmp_lg_u32 s21, 20
s_cbranch_scc1 l1_kernel_rf20
buffer_store_dwordx4 v[208:211], v1, s[8:11], s3 offen sc1
l1_kernel_rf20:
s_cmp_lg_u32 s21, 21
s_cbranch_scc1 l1_kernel_rf21
buffer_store_dwordx4 v[212:215], v1, s[8:11], s3 offen sc1
l1_kernel_rf21:
s_cmp_lg_u32 s21, 22
s_cbranch_scc1 l1_kernel_rf22
buffer_store_dwordx4 v[216:219], v1, s[8:11], s3 offen sc1
l1_kernel_rf22:
s_cmp_lg_u32 s21, 23
s_cbranch_scc1 l1_kernel_rf23
buffer_store_dwordx4 v[220:223], v1, s[8:11], s3 offen sc1
l1_kernel_rf23:
s_cmp_lg_u32 s21, 24
s_cbranch_scc1 l1_kernel_rf24
buffer_store_dwordx4 v[224:227], v1, s[8:11], s3 offen sc1
l1_kernel_rf24:
l1_kernel_norf:
s_cmp_lg_u32 s21, 25
s_cbranch_scc1 l1_kernel_norho
s_lshl_b32 s3, s22, 2
s_add_u32 s3, s3, s20
s_lshl_b32 s3, s3, 9
s_add_u32 s3, s3, 45498368
v_lshrrev_b32 v4, 2, v1
buffer_store_dword v254, v4, s[8:11], s3 offen sc1
buffer_store_dword v255, v4, s[8:11], s3 offen offset:256 sc1
l1_kernel_norho:
s_mul_i32 s36, s21, 40960
s_mul_i32 s3, s20, 5120
s_add_u32 s36, s36, s3
s_add_u32 s36, s36, 0
s_add_u32 s37, s36, 20480
s_cmp_eq_u32 s20, s22
s_cselect_b32 s38, 268435456, 0
s_mov_b32 s24, s8
s_mov_b32 s25, s9
s_mov_b32 s26, s38
s_mov_b32 s27, 0x20000
ds_read_b128 v[32:35], v236 offset:0
ds_read_b128 v[36:39], v236 offset:640
ds_read_b128 v[40:43], v236 offset:32
ds_read_b128 v[44:47], v236 offset:672
ds_read_b128 v[48:51], v236 offset:64
ds_read_b128 v[52:55], v236 offset:704
s_waitcnt lgkmcnt(5)
v_mfma_f32_32x32x16_bf16 v[64:79], v[32:35], v[128:131], 0
v_mfma_f32_32x32x16_bf16 v[96:111], v[32:35], v[208:211], 0
s_waitcnt lgkmcnt(4)
v_mfma_f32_32x32x16_bf16 v[80:95], v[36:39], v[128:131], 0
v_mfma_f32_32x32x16_bf16 v[112:127], v[36:39], v[208:211], 0
buffer_store_dwordx4 v[32:35], v1, s[24:27], s36 offen offset:0 sc1
buffer_store_dwordx4 v[36:39], v1, s[24:27], s37 offen offset:0 sc1
ds_read_b128 v[56:59], v236 offset:96
ds_read_b128 v[60:63], v236 offset:736
s_waitcnt lgkmcnt(5)
v_mfma_f32_32x32x16_bf16 v[64:79], v[40:43], v[132:135], v[64:79]
v_mfma_f32_32x32x16_bf16 v[96:111], v[40:43], v[212:215], v[96:111]
s_waitcnt lgkmcnt(4)
v_mfma_f32_32x32x16_bf16 v[80:95], v[44:47], v[132:135], v[80:95]
v_mfma_f32_32x32x16_bf16 v[112:127], v[44:47], v[212:215], v[112:127]
buffer_store_dwordx4 v[40:43], v1, s[24:27], s36 offen offset:1024 sc1
buffer_store_dwordx4 v[44:47], v1, s[24:27], s37 offen offset:1024 sc1
ds_read_b128 v[32:35], v236 offset:128
ds_read_b128 v[36:39], v236 offset:768
s_waitcnt lgkmcnt(5)
v_mfma_f32_32x32x16_bf16 v[64:79], v[48:51], v[136:139], v[64:79]
v_mfma_f32_32x32x16_bf16 v[96:111], v[48:51], v[216:219], v[96:111]
s_waitcnt lgkmcnt(4)
v_mfma_f32_32x32x16_bf16 v[80:95], v[52:55], v[136:139], v[80:95]
v_mfma_f32_32x32x16_bf16 v[112:127], v[52:55], v[216:219], v[112:127]
buffer_store_dwordx4 v[48:51], v1, s[24:27], s36 offen offset:2048 sc1
buffer_store_dwordx4 v[52:55], v1, s[24:27], s37 offen offset:2048 sc1
ds_read_b128 v[40:43], v237 offset:0
ds_read_b128 v[44:47], v237 offset:640
s_waitcnt lgkmcnt(5)
v_mfma_f32_32x32x16_bf16 v[64:79], v[56:59], v[140:143], v[64:79]
v_mfma_f32_32x32x16_bf16 v[96:111], v[56:59], v[220:223], v[96:111]
s_waitcnt lgkmcnt(4)
v_mfma_f32_32x32x16_bf16 v[80:95], v[60:63], v[140:143], v[80:95]
v_mfma_f32_32x32x16_bf16 v[112:127], v[60:63], v[220:223], v[112:127]
buffer_store_dwordx4 v[56:59], v1, s[24:27], s36 offen offset:3072 sc1
buffer_store_dwordx4 v[60:63], v1, s[24:27], s37 offen offset:3072 sc1
ds_read_b128 v[48:51], v237 offset:32
ds_read_b128 v[52:55], v237 offset:672
s_waitcnt lgkmcnt(5)
v_mfma_f32_32x32x16_bf16 v[64:79], v[32:35], v[144:147], v[64:79]
v_mfma_f32_32x32x16_bf16 v[96:111], v[32:35], v[224:227], v[96:111]
s_waitcnt lgkmcnt(4)
v_mfma_f32_32x32x16_bf16 v[80:95], v[36:39], v[144:147], v[80:95]
v_mfma_f32_32x32x16_bf16 v[112:127], v[36:39], v[224:227], v[112:127]
s_add_u32 s36, s36, 4096
s_add_u32 s37, s37, 4096
buffer_store_dwordx4 v[32:35], v1, s[24:27], s36 offen offset:0 sc1
buffer_store_dwordx4 v[36:39], v1, s[24:27], s37 offen offset:0 sc1
ds_read_b128 v[56:59], v237 offset:64
ds_read_b128 v[60:63], v237 offset:704
s_waitcnt lgkmcnt(5)
v_mfma_f32_32x32x16_bf16 v[64:79], v[40:43], v[148:151], v[64:79]
s_waitcnt lgkmcnt(4)
v_mfma_f32_32x32x16_bf16 v[80:95], v[44:47], v[148:151], v[80:95]
ds_read_b128 v[32:35], v237 offset:96
ds_read_b128 v[36:39], v237 offset:736
s_waitcnt lgkmcnt(5)
v_mfma_f32_32x32x16_bf16 v[64:79], v[48:51], v[152:155], v[64:79]
s_waitcnt lgkmcnt(4)
v_mfma_f32_32x32x16_bf16 v[80:95], v[52:55], v[152:155], v[80:95]
ds_read_b128 v[40:43], v237 offset:128
ds_read_b128 v[44:47], v237 offset:768
s_waitcnt lgkmcnt(5)
v_mfma_f32_32x32x16_bf16 v[64:79], v[56:59], v[156:159], v[64:79]
s_waitcnt lgkmcnt(4)
v_mfma_f32_32x32x16_bf16 v[80:95], v[60:63], v[156:159], v[80:95]
ds_read_b128 v[48:51], v238 offset:0
ds_read_b128 v[52:55], v238 offset:640
s_waitcnt lgkmcnt(5)
v_mfma_f32_32x32x16_bf16 v[64:79], v[32:35], v[160:163], v[64:79]
s_waitcnt lgkmcnt(4)
v_mfma_f32_32x32x16_bf16 v[80:95], v[36:39], v[160:163], v[80:95]
ds_read_b128 v[56:59], v238 offset:32
ds_read_b128 v[60:63], v238 offset:672
s_waitcnt lgkmcnt(5)
v_mfma_f32_32x32x16_bf16 v[64:79], v[40:43], v[164:167], v[64:79]
s_waitcnt lgkmcnt(4)
v_mfma_f32_32x32x16_bf16 v[80:95], v[44:47], v[164:167], v[80:95]
ds_read_b128 v[32:35], v238 offset:64
ds_read_b128 v[36:39], v238 offset:704
s_waitcnt lgkmcnt(5)
v_mfma_f32_32x32x16_bf16 v[64:79], v[48:51], v[168:171], v[64:79]
s_waitcnt lgkmcnt(4)
v_mfma_f32_32x32x16_bf16 v[80:95], v[52:55], v[168:171], v[80:95]
ds_read_b128 v[40:43], v238 offset:96
ds_read_b128 v[44:47], v238 offset:736
s_waitcnt lgkmcnt(5)
v_mfma_f32_32x32x16_bf16 v[64:79], v[56:59], v[172:175], v[64:79]
s_waitcnt lgkmcnt(4)
v_mfma_f32_32x32x16_bf16 v[80:95], v[60:63], v[172:175], v[80:95]
ds_read_b128 v[48:51], v238 offset:128
ds_read_b128 v[52:55], v238 offset:768
s_waitcnt lgkmcnt(5)
v_mfma_f32_32x32x16_bf16 v[64:79], v[32:35], v[176:179], v[64:79]
s_waitcnt lgkmcnt(4)
v_mfma_f32_32x32x16_bf16 v[80:95], v[36:39], v[176:179], v[80:95]
ds_read_b128 v[56:59], v239 offset:0
ds_read_b128 v[60:63], v239 offset:640
s_waitcnt lgkmcnt(5)
v_mfma_f32_32x32x16_bf16 v[64:79], v[40:43], v[180:183], v[64:79]
s_waitcnt lgkmcnt(4)
v_mfma_f32_32x32x16_bf16 v[80:95], v[44:47], v[180:183], v[80:95]
ds_read_b128 v[32:35], v239 offset:32
ds_read_b128 v[36:39], v239 offset:672
s_waitcnt lgkmcnt(5)
v_mfma_f32_32x32x16_bf16 v[64:79], v[48:51], v[184:187], v[64:79]
s_waitcnt lgkmcnt(4)
v_mfma_f32_32x32x16_bf16 v[80:95], v[52:55], v[184:187], v[80:95]
ds_read_b128 v[40:43], v239 offset:64
ds_read_b128 v[44:47], v239 offset:704
s_waitcnt lgkmcnt(5)
v_mfma_f32_32x32x16_bf16 v[64:79], v[56:59], v[188:191], v[64:79]
s_waitcnt lgkmcnt(4)
v_mfma_f32_32x32x16_bf16 v[80:95], v[60:63], v[188:191], v[80:95]
ds_read_b128 v[48:51], v239 offset:96
ds_read_b128 v[52:55], v239 offset:736
s_waitcnt lgkmcnt(5)
v_mfma_f32_32x32x16_bf16 v[64:79], v[32:35], v[192:195], v[64:79]
s_waitcnt lgkmcnt(4)
v_mfma_f32_32x32x16_bf16 v[80:95], v[36:39], v[192:195], v[80:95]
ds_read_b128 v[56:59], v239 offset:128
ds_read_b128 v[60:63], v239 offset:768
s_waitcnt lgkmcnt(5)
v_mfma_f32_32x32x16_bf16 v[64:79], v[40:43], v[196:199], v[64:79]
s_waitcnt lgkmcnt(4)
v_mfma_f32_32x32x16_bf16 v[80:95], v[44:47], v[196:199], v[80:95]
ds_read_b128 v[32:35], v253 offset:640
s_waitcnt lgkmcnt(4)
v_mfma_f32_32x32x16_bf16 v[64:79], v[48:51], v[200:203], v[64:79]
s_waitcnt lgkmcnt(3)
v_mfma_f32_32x32x16_bf16 v[80:95], v[52:55], v[200:203], v[80:95]
s_waitcnt lgkmcnt(2)
v_mfma_f32_32x32x16_bf16 v[64:79], v[56:59], v[204:207], v[64:79]
s_waitcnt lgkmcnt(1)
v_mfma_f32_32x32x16_bf16 v[80:95], v[60:63], v[204:207], v[80:95]
s_waitcnt lgkmcnt(0)
v_and_b32 v32, 0xffff, v32
v_or_b32 v32, v32, v245
v_mov_b32 v33, v246
v_mov_b32 v34, 0
v_mov_b32 v35, 0
s_nop 1
v_mfma_f32_32x32x16_bf16 v[80:95], v[32:35], v[228:231], v[80:95]
v_mfma_f32_32x32x16_bf16 v[112:127], v[32:35], v[232:235], v[112:127]
v_cmp_gt_u32 vcc, 16, v2
v_mov_b32 v4, -1.0
s_nop 0
v_cndmask_b32 v240, v4, 1.0, vcc
s_mov_b32 s3, 41472
v_lshl_add_u32 v5, v3, 4, s3
ds_read_b128 v[128:131], v5 offset:0
ds_read_b128 v[132:135], v5 offset:32
ds_read_b128 v[136:139], v5 offset:64
ds_read_b128 v[140:143], v5 offset:96
s_nop 1
v_fma_f32 v96, v112, v240, v96
v_fma_f32 v97, v113, v240, v97
v_fma_f32 v98, v114, v240, v98
v_fma_f32 v99, v115, v240, v99
v_fma_f32 v100, v116, v240, v100
v_fma_f32 v101, v117, v240, v101
v_fma_f32 v102, v118, v240, v102
v_fma_f32 v103, v119, v240, v103
v_fma_f32 v104, v120, v240, v104
v_fma_f32 v105, v121, v240, v105
v_fma_f32 v106, v122, v240, v106
v_fma_f32 v107, v123, v240, v107
v_fma_f32 v108, v124, v240, v108
v_fma_f32 v109, v125, v240, v109
v_fma_f32 v110, v126, v240, v110
v_fma_f32 v111, v127, v240, v111
s_lshl_b32 s3, s20, 12
s_add_u32 s3, s3, 42496
v_add_u32 v6, s3, v1
ds_write_b128 v6, v[96:99] offset:0
ds_write_b128 v6, v[100:103] offset:1024
ds_write_b128 v6, v[104:107] offset:2048
ds_write_b128 v6, v[108:111] offset:3072
v_fma_f32 v64, v80, v240, v64
v_fma_f32 v65, v81, v240, v65
v_fma_f32 v66, v82, v240, v66
v_fma_f32 v67, v83, v240, v67
v_fma_f32 v68, v84, v240, v68
v_fma_f32 v69, v85, v240, v69
v_fma_f32 v70, v86, v240, v70
v_fma_f32 v71, v87, v240, v71
v_fma_f32 v72, v88, v240, v72
v_fma_f32 v73, v89, v240, v73
v_fma_f32 v74, v90, v240, v74
v_fma_f32 v75, v91, v240, v75
v_fma_f32 v76, v92, v240, v76
v_fma_f32 v77, v93, v240, v77
v_fma_f32 v78, v94, v240, v78
v_fma_f32 v79, v95, v240, v79
s_lshl_b32 s3, s20, 11
s_add_u32 s3, s3, 58880
v_lshlrev_b32 v241, 6, v2
v_lshl_add_u32 v241, v3, 4, v241
v_add_u32 v241, s3, v241
v_add_u32 v242, s3, v1
s_mul_i32 s6, s23, 20
s_mul_i32 s4, s22, 5
s_add_u32 s6, s6, s4
s_add_u32 s5, s6, s20
s_lshl_b32 s5, s5, 11
s_add_u32 s5, s5, 12582912
s_add_u32 s4, s6, 4
s_lshl_b32 s4, s4, 11
s_add_u32 s4, s4, 12582912
s_waitcnt lgkmcnt(0)
s_barrier
s_cmp_lg_u32 s20, 3
s_cbranch_scc1 l1_kernel_f1nr
v_add_u32 v6, 42496, v1
ds_read_b128 v[80:83], v6 offset:0
ds_read_b128 v[84:87], v6 offset:1024
ds_read_b128 v[88:91], v6 offset:2048
ds_read_b128 v[92:95], v6 offset:3072
ds_read_b128 v[112:115], v6 offset:4096
ds_read_b128 v[116:119], v6 offset:5120
ds_read_b128 v[120:123], v6 offset:6144
ds_read_b128 v[124:127], v6 offset:7168
ds_read_b128 v[32:35], v6 offset:8192
ds_read_b128 v[36:39], v6 offset:9216
ds_read_b128 v[40:43], v6 offset:10240
ds_read_b128 v[44:47], v6 offset:11264
l1_kernel_f1nr:
v_mul_f32 v64, v64, v128
v_mul_f32 v65, v65, v129
v_mul_f32 v66, v66, v130
v_mul_f32 v67, v67, v131
v_mul_f32 v68, v68, v132
v_mul_f32 v69, v69, v133
v_mul_f32 v70, v70, v134
v_mul_f32 v71, v71, v135
v_mul_f32 v72, v72, v136
v_mul_f32 v73, v73, v137
v_mul_f32 v74, v74, v138
v_mul_f32 v75, v75, v139
v_mul_f32 v76, v76, v140
v_mul_f32 v77, v77, v141
v_mul_f32 v78, v78, v142
v_mul_f32 v79, v79, v143
v_cvt_pk_f16_f32 v176, v64, v65
v_cvt_pk_f16_f32 v177, v66, v67
v_cvt_pk_f16_f32 v178, v68, v69
v_cvt_pk_f16_f32 v179, v70, v71
v_cvt_pk_f16_f32 v180, v72, v73
v_cvt_pk_f16_f32 v181, v74, v75
v_cvt_pk_f16_f32 v182, v76, v77
v_cvt_pk_f16_f32 v183, v78, v79
v_mfma_f32_32x32x16_f16 v[144:159], v[176:179], v[16:19], 0
v_mfma_f32_32x32x16_f16 v[160:175], v[176:179], v[24:27], 0
v_mfma_f32_32x32x16_f16 v[144:159], v[180:183], v[20:23], v[144:159]
v_mfma_f32_32x32x16_f16 v[160:175], v[180:183], v[28:31], v[160:175]
s_nop 11
v_sub_f32 v64, v144, v168
v_add_f32 v72, v160, v152
v_sub_f32 v65, v145, v169
v_add_f32 v73, v161, v153
v_sub_f32 v66, v146, v170
v_add_f32 v74, v162, v154
v_sub_f32 v67, v147, v171
v_add_f32 v75, v163, v155
v_sub_f32 v68, v148, v172
v_add_f32 v76, v164, v156
v_sub_f32 v69, v149, v173
v_add_f32 v77, v165, v157
v_sub_f32 v70, v150, v174
v_add_f32 v78, v166, v158
v_sub_f32 v71, v151, v175
v_add_f32 v79, v167, v159
v_cvt_pk_f16_f32 v176, v64, v65
v_cvt_pk_f16_f32 v180, v72, v73
v_cvt_pk_f16_f32 v177, v66, v67
v_cvt_pk_f16_f32 v181, v74, v75
v_cvt_pk_f16_f32 v178, v68, v69
v_cvt_pk_f16_f32 v182, v76, v77
v_cvt_pk_f16_f32 v179, v70, v71
v_cvt_pk_f16_f32 v183, v78, v79
ds_write_b128 v241, v[176:179]
ds_write_b128 v241, v[180:183] offset:32
s_waitcnt lgkmcnt(0)
ds_read_b128 v[176:179], v242
ds_read_b128 v[180:183], v242 offset:1024
s_waitcnt lgkmcnt(0)
buffer_store_dwordx4 v[176:179], v1, s[8:11], s5 offen sc1
buffer_store_dwordx4 v[180:183], v1, s[8:11], s5 offen offset:1024 sc1
s_cmp_lg_u32 s20, 3
s_cbranch_scc1 l1_kernel_f1done
s_waitcnt lgkmcnt(0)
v_add_f32 v96, v96, v80
v_add_f32 v97, v97, v81
v_add_f32 v98, v98, v82
v_add_f32 v99, v99, v83
v_add_f32 v100, v100, v84
v_add_f32 v101, v101, v85
v_add_f32 v102, v102, v86
v_add_f32 v103, v103, v87
v_add_f32 v104, v104, v88
v_add_f32 v105, v105, v89
v_add_f32 v106, v106, v90
v_add_f32 v107, v107, v91
v_add_f32 v108, v108, v92
v_add_f32 v109, v109, v93
v_add_f32 v110, v110, v94
v_add_f32 v111, v111, v95
v_add_f32 v96, v96, v112
v_add_f32 v97, v97, v113
v_add_f32 v98, v98, v114
v_add_f32 v99, v99, v115
v_add_f32 v100, v100, v116
v_add_f32 v101, v101, v117
v_add_f32 v102, v102, v118
v_add_f32 v103, v103, v119
v_add_f32 v104, v104, v120
v_add_f32 v105, v105, v121
v_add_f32 v106, v106, v122
v_add_f32 v107, v107, v123
v_add_f32 v108, v108, v124
v_add_f32 v109, v109, v125
v_add_f32 v110, v110, v126
v_add_f32 v111, v111, v127
v_add_f32 v96, v96, v32
v_add_f32 v97, v97, v33
v_add_f32 v98, v98, v34
v_add_f32 v99, v99, v35
v_add_f32 v100, v100, v36
v_add_f32 v101, v101, v37
v_add_f32 v102, v102, v38
v_add_f32 v103, v103, v39
v_add_f32 v104, v104, v40
v_add_f32 v105, v105, v41
v_add_f32 v106, v106, v42
v_add_f32 v107, v107, v43
v_add_f32 v108, v108, v44
v_add_f32 v109, v109, v45
v_add_f32 v110, v110, v46
v_add_f32 v111, v111, v47
v_mul_f32 v96, v96, v128
v_mul_f32 v97, v97, v129
v_mul_f32 v98, v98, v130
v_mul_f32 v99, v99, v131
v_mul_f32 v100, v100, v132
v_mul_f32 v101, v101, v133
v_mul_f32 v102, v102, v134
v_mul_f32 v103, v103, v135
v_mul_f32 v104, v104, v136
v_mul_f32 v105, v105, v137
v_mul_f32 v106, v106, v138
v_mul_f32 v107, v107, v139
v_mul_f32 v108, v108, v140
v_mul_f32 v109, v109, v141
v_mul_f32 v110, v110, v142
v_mul_f32 v111, v111, v143
v_cvt_pk_f16_f32 v184, v96, v97
v_cvt_pk_f16_f32 v185, v98, v99
v_cvt_pk_f16_f32 v186, v100, v101
v_cvt_pk_f16_f32 v187, v102, v103
v_cvt_pk_f16_f32 v188, v104, v105
v_cvt_pk_f16_f32 v189, v106, v107
v_cvt_pk_f16_f32 v190, v108, v109
v_cvt_pk_f16_f32 v191, v110, v111
v_mfma_f32_32x32x16_f16 v[144:159], v[184:187], v[16:19], 0
v_mfma_f32_32x32x16_f16 v[160:175], v[184:187], v[24:27], 0
v_mfma_f32_32x32x16_f16 v[144:159], v[188:191], v[20:23], v[144:159]
v_mfma_f32_32x32x16_f16 v[160:175], v[188:191], v[28:31], v[160:175]
s_nop 11
v_sub_f32 v96, v144, v168
v_add_f32 v104, v160, v152
v_sub_f32 v97, v145, v169
v_add_f32 v105, v161, v153
v_sub_f32 v98, v146, v170
v_add_f32 v106, v162, v154
v_sub_f32 v99, v147, v171
v_add_f32 v107, v163, v155
v_sub_f32 v100, v148, v172
v_add_f32 v108, v164, v156
v_sub_f32 v101, v149, v173
v_add_f32 v109, v165, v157
v_sub_f32 v102, v150, v174
v_add_f32 v110, v166, v158
v_sub_f32 v103, v151, v175
v_add_f32 v111, v167, v159
v_cvt_pk_f16_f32 v184, v96, v97
v_cvt_pk_f16_f32 v188, v104, v105
v_cvt_pk_f16_f32 v185, v98, v99
v_cvt_pk_f16_f32 v189, v106, v107
v_cvt_pk_f16_f32 v186, v100, v101
v_cvt_pk_f16_f32 v190, v108, v109
v_cvt_pk_f16_f32 v187, v102, v103
v_cvt_pk_f16_f32 v191, v110, v111
ds_write_b128 v241, v[184:187]
ds_write_b128 v241, v[188:191] offset:32
s_waitcnt lgkmcnt(0)
ds_read_b128 v[184:187], v242
ds_read_b128 v[188:191], v242 offset:1024
s_waitcnt lgkmcnt(0)
buffer_store_dwordx4 v[184:187], v1, s[8:11], s4 offen sc1
buffer_store_dwordx4 v[188:191], v1, s[8:11], s4 offen offset:1024 sc1
l1_kernel_f1done:
s_branch l1_kernel_end
l1_kernel_prep:
s_sub_u32 s33, s2, 256
s_lshl_b32 s33, s33, 2
s_add_u32 s33, s33, s20
s_add_u32 s35, s33, 540
s_sub_u32 s36, s33, 270
s_cmp_lt_u32 s33, 270
s_cselect_b32 s35, s35, s36
s_cmp_lt_u32 s33, 810
s_cselect_b32 s33, s35, s33
s_waitcnt lgkmcnt(0)
s_mov_b32 s8, s4
s_mov_b32 s9, s5
s_mov_b32 s10, 268435456
s_mov_b32 s11, 0x20000
s_cmp_ge_u32 s33, 810
s_cselect_b32 s24, 2, 0
s_cbranch_scc1 l1_kernel_pi_done
v_and_b32 v4, 7, v0
v_bfe_u32 v5, v0, 3, 3
s_cmp_ge_u32 s33, 540
s_cbranch_scc1 l1_kernel_pi_wd
s_and_b32 s25, s33, 1
s_lshr_b32 s3, s33, 1
s_mul_hi_u32 s27, s3, 159072863
s_mul_i32 s4, s27, 27
s_sub_u32 s26, s3, s4
s_cmp_eq_u32 s25, 1
s_cselect_b32 s28, s46, s44
s_cselect_b32 s29, s47, s45
s_mov_b32 s30, 2211840
s_mov_b32 s31, 0x20000
s_lshl_b32 s3, s26, 7
v_lshlrev_b32 v6, 4, v4
v_add_u32 v6, s3, v6
s_lshl_b32 s3, s27, 6
v_lshl_add_u32 v7, v5, 3, s3
v_add_u32 v8, 0, v7
v_sub_u32 v9, 960, v8
v_cmp_lt_u32 vcc, 320, v8
s_nop 1
v_cndmask_b32 v8, v8, v9, vcc
v_mul_u32_u24 v8, 3456, v8
v_add_u32 v8, v8, v6
buffer_load_dwordx4 v[16:19], v8, s[28:31], 0 offen
v_add_u32 v8, 1, v7
v_sub_u32 v9, 960, v8
v_cmp_lt_u32 vcc, 320, v8
s_nop 1
v_cndmask_b32 v8, v8, v9, vcc
v_mul_u32_u24 v8, 3456, v8
v_add_u32 v8, v8, v6
buffer_load_dwordx4 v[20:23], v8, s[28:31], 0 offen
v_add_u32 v8, 2, v7
v_sub_u32 v9, 960, v8
v_cmp_lt_u32 vcc, 320, v8
s_nop 1
v_cndmask_b32 v8, v8, v9, vcc
v_mul_u32_u24 v8, 3456, v8
v_add_u32 v8, v8, v6
buffer_load_dwordx4 v[24:27], v8, s[28:31], 0 offen
v_add_u32 v8, 3, v7
v_sub_u32 v9, 960, v8
v_cmp_lt_u32 vcc, 320, v8
s_nop 1
v_cndmask_b32 v8, v8, v9, vcc
v_mul_u32_u24 v8, 3456, v8
v_add_u32 v8, v8, v6
buffer_load_dwordx4 v[28:31], v8, s[28:31], 0 offen
v_add_u32 v8, 4, v7
v_sub_u32 v9, 960, v8
v_cmp_lt_u32 vcc, 320, v8
s_nop 1
v_cndmask_b32 v8, v8, v9, vcc
v_mul_u32_u24 v8, 3456, v8
v_add_u32 v8, v8, v6
buffer_load_dwordx4 v[32:35], v8, s[28:31], 0 offen
v_add_u32 v8, 5, v7
v_sub_u32 v9, 960, v8
v_cmp_lt_u32 vcc, 320, v8
s_nop 1
v_cndmask_b32 v8, v8, v9, vcc
v_mul_u32_u24 v8, 3456, v8
v_add_u32 v8, v8, v6
buffer_load_dwordx4 v[36:39], v8, s[28:31], 0 offen
v_add_u32 v8, 6, v7
v_sub_u32 v9, 960, v8
v_cmp_lt_u32 vcc, 320, v8
s_nop 1
v_cndmask_b32 v8, v8, v9, vcc
v_mul_u32_u24 v8, 3456, v8
v_add_u32 v8, v8, v6
buffer_load_dwordx4 v[40:43], v8, s[28:31], 0 offen
v_add_u32 v8, 7, v7
v_sub_u32 v9, 960, v8
v_cmp_lt_u32 vcc, 320, v8
s_nop 1
v_cndmask_b32 v8, v8, v9, vcc
v_mul_u32_u24 v8, 3456, v8
v_add_u32 v8, v8, v6
buffer_load_dwordx4 v[44:47], v8, s[28:31], 0 offen
s_branch l1_kernel_pi_done
l1_kernel_pi_wd:
s_mov_b32 s24, 1
s_sub_u32 s3, s33, 540
s_mul_hi_u32 s26, s3, 429496730
s_mul_i32 s4, s26, 10
s_sub_u32 s25, s3, s4
s_mov_b32 s28, s48
s_mov_b32 s29, s49
s_mov_b32 s30, 2211840
s_mov_b32 s31, 0x20000
s_lshl_b32 s3, s26, 6
v_lshl_add_u32 v7, v5, 3, s3
s_lshl_b32 s3, s25, 6
v_lshl_add_u32 v6, v4, 3, s3
v_mul_u32_u24 v8, 1280, v7
v_lshl_add_u32 v8, v6, 1, v8
buffer_load_dwordx4 v[16:19], v8, s[28:31], 0 offen
v_add_u32 v8, 1280, v8
buffer_load_dwordx4 v[20:23], v8, s[28:31], 0 offen
v_add_u32 v8, 1280, v8
buffer_load_dwordx4 v[24:27], v8, s[28:31], 0 offen
v_add_u32 v8, 1280, v8
buffer_load_dwordx4 v[28:31], v8, s[28:31], 0 offen
v_add_u32 v8, 1280, v8
buffer_load_dwordx4 v[32:35], v8, s[28:31], 0 offen
v_add_u32 v8, 1280, v8
buffer_load_dwordx4 v[36:39], v8, s[28:31], 0 offen
v_add_u32 v8, 1280, v8
buffer_load_dwordx4 v[40:43], v8, s[28:31], 0 offen
v_add_u32 v8, 1280, v8
buffer_load_dwordx4 v[44:47], v8, s[28:31], 0 offen
v_add_u32 v8, 1280, v8
l1_kernel_pi_done:
s_waitcnt vmcnt(0)
s_cmp_eq_u32 s24, 2
s_cbranch_scc1 l1_kernel_pf_done
s_mov_b32 s30, 0x05040100
s_mov_b32 s31, 0x07060302
v_and_b32 v4, 7, v0
v_bfe_u32 v5, v0, 3, 3
v_perm_b32 v48, v20, v16, s30
v_perm_b32 v49, v28, v24, s30
v_perm_b32 v50, v36, v32, s30
v_perm_b32 v51, v44, v40, s30
v_perm_b32 v52, v20, v16, s31
v_perm_b32 v53, v28, v24, s31
v_perm_b32 v54, v36, v32, s31
v_perm_b32 v55, v44, v40, s31
v_perm_b32 v56, v21, v17, s30
v_perm_b32 v57, v29, v25, s30
v_perm_b32 v58, v37, v33, s30
v_perm_b32 v59, v45, v41, s30
v_perm_b32 v60, v21, v17, s31
v_perm_b32 v61, v29, v25, s31
v_perm_b32 v62, v37, v33, s31
v_perm_b32 v63, v45, v41, s31
v_perm_b32 v64, v22, v18, s30
v_perm_b32 v65, v30, v26, s30
v_perm_b32 v66, v38, v34, s30
v_perm_b32 v67, v46, v42, s30
v_perm_b32 v68, v22, v18, s31
v_perm_b32 v69, v30, v26, s31
v_perm_b32 v70, v38, v34, s31
v_perm_b32 v71, v46, v42, s31
v_perm_b32 v72, v23, v19, s30
v_perm_b32 v73, v31, v27, s30
v_perm_b32 v74, v39, v35, s30
v_perm_b32 v75, v47, v43, s30
v_perm_b32 v76, v23, v19, s31
v_perm_b32 v77, v31, v27, s31
v_perm_b32 v78, v39, v35, s31
v_perm_b32 v79, v47, v43, s31
s_cmp_eq_u32 s24, 1
s_cbranch_scc1 l1_kernel_pf_wd
v_lshrrev_b32 v7, 1, v4
v_mul_u32_u24 v10, 2064, v7
v_lshrrev_b32 v9, 1, v5
v_lshl_add_u32 v10, v9, 9, v10
v_and_b32 v9, 1, v5
v_lshl_add_u32 v10, v9, 8, v10
v_and_b32 v8, 1, v4
v_lshl_add_u32 v10, v8, 6, v10
s_mul_i32 s3, s20, 8448
v_add_u32 v10, s3, v10
v_and_b32 v11, 63, v0
v_lshl_add_u32 v12, v11, 4, s3
ds_write_b128 v10, v[48:51] offset:0
ds_write_b128 v10, v[52:55] offset:16
ds_write_b128 v10, v[56:59] offset:32
ds_write_b128 v10, v[60:63] offset:48
ds_write_b128 v10, v[64:67] offset:128
ds_write_b128 v10, v[68:71] offset:144
ds_write_b128 v10, v[72:75] offset:160
ds_write_b128 v10, v[76:79] offset:176
v_lshrrev_b32 v13, 5, v11
v_lshlrev_b32 v13, 10, v13
v_bfe_u32 v14, v11, 4, 1
v_lshl_add_u32 v13, v14, 9, v13
v_and_b32 v14, 15, v11
v_lshl_add_u32 v13, v14, 4, v13
s_lshl_b32 s3, s26, 2
s_mul_i32 s3, s3, 40960
s_lshl_b32 s4, s27, 12
s_add_u32 s3, s3, s4
s_lshl_b32 s4, s25, 8
s_add_u32 s3, s3, s4
s_add_u32 s3, s3, 33554432
s_lshl_b32 s4, s26, 2
v_add_u32 v7, s4, v7
s_waitcnt lgkmcnt(0)
ds_read_b128 v[16:19], v12 offset:0
ds_read_b128 v[20:23], v12 offset:1024
ds_read_b128 v[24:27], v12 offset:2064
ds_read_b128 v[28:31], v12 offset:3088
ds_read_b128 v[32:35], v12 offset:4128
ds_read_b128 v[36:39], v12 offset:5152
ds_read_b128 v[40:43], v12 offset:6192
ds_read_b128 v[44:47], v12 offset:7216
s_waitcnt lgkmcnt(7)
buffer_store_dwordx4 v[16:19], v13, s[8:11], s3 offen offset:0 sc1
s_waitcnt lgkmcnt(6)
buffer_store_dwordx4 v[20:23], v13, s[8:11], s3 offen offset:2048 sc1
s_add_u32 s3, s3, 40960
s_waitcnt lgkmcnt(5)
buffer_store_dwordx4 v[24:27], v13, s[8:11], s3 offen offset:0 sc1
s_waitcnt lgkmcnt(4)
buffer_store_dwordx4 v[28:31], v13, s[8:11], s3 offen offset:2048 sc1
s_add_u32 s3, s3, 40960
s_waitcnt lgkmcnt(3)
buffer_store_dwordx4 v[32:35], v13, s[8:11], s3 offen offset:0 sc1
s_waitcnt lgkmcnt(2)
buffer_store_dwordx4 v[36:39], v13, s[8:11], s3 offen offset:2048 sc1
s_add_u32 s3, s3, 40960
s_waitcnt lgkmcnt(1)
buffer_store_dwordx4 v[40:43], v13, s[8:11], s3 offen offset:0 sc1
s_waitcnt lgkmcnt(0)
buffer_store_dwordx4 v[44:47], v13, s[8:11], s3 offen offset:2048 sc1
s_add_u32 s3, s3, 40960
v_mov_b32 v80, 0
v_mov_b32 v81, 0
v_mov_b32 v82, 0
v_mov_b32 v83, 0
v_mov_b32 v84, 0
v_mov_b32 v85, 0
v_mov_b32 v86, 0
v_mov_b32 v87, 0
v_mov_b32 v88, 0x3f803f80
v_dot2c_f32_bf16 v80, v48, v88
v_dot2c_f32_bf16 v81, v52, v88
v_dot2c_f32_bf16 v82, v56, v88
v_dot2c_f32_bf16 v83, v60, v88
v_dot2c_f32_bf16 v84, v64, v88
v_dot2c_f32_bf16 v85, v68, v88
v_dot2c_f32_bf16 v86, v72, v88
v_dot2c_f32_bf16 v87, v76, v88
v_dot2c_f32_bf16 v80, v49, v88
v_dot2c_f32_bf16 v81, v53, v88
v_dot2c_f32_bf16 v82, v57, v88
v_dot2c_f32_bf16 v83, v61, v88
v_dot2c_f32_bf16 v84, v65, v88
v_dot2c_f32_bf16 v85, v69, v88
v_dot2c_f32_bf16 v86, v73, v88
v_dot2c_f32_bf16 v87, v77, v88
v_dot2c_f32_bf16 v80, v50, v88
v_dot2c_f32_bf16 v81, v54, v88
v_dot2c_f32_bf16 v82, v58, v88
v_dot2c_f32_bf16 v83, v62, v88
v_dot2c_f32_bf16 v84, v66, v88
v_dot2c_f32_bf16 v85, v70, v88
v_dot2c_f32_bf16 v86, v74, v88
v_dot2c_f32_bf16 v87, v78, v88
v_dot2c_f32_bf16 v80, v51, v88
v_dot2c_f32_bf16 v81, v55, v88
v_dot2c_f32_bf16 v82, v59, v88
v_dot2c_f32_bf16 v83, v63, v88
v_dot2c_f32_bf16 v84, v67, v88
v_dot2c_f32_bf16 v85, v71, v88
v_dot2c_f32_bf16 v86, v75, v88
v_dot2c_f32_bf16 v87, v79, v88
s_nop 2
v_add_f32_dpp v80, v80, v80 row_ror:8 row_mask:0xf bank_mask:0xf
v_add_f32_dpp v81, v81, v81 row_ror:8 row_mask:0xf bank_mask:0xf
v_add_f32_dpp v82, v82, v82 row_ror:8 row_mask:0xf bank_mask:0xf
v_add_f32_dpp v83, v83, v83 row_ror:8 row_mask:0xf bank_mask:0xf
v_add_f32_dpp v84, v84, v84 row_ror:8 row_mask:0xf bank_mask:0xf
v_add_f32_dpp v85, v85, v85 row_ror:8 row_mask:0xf bank_mask:0xf
v_add_f32_dpp v86, v86, v86 row_ror:8 row_mask:0xf bank_mask:0xf
v_add_f32_dpp v87, v87, v87 row_ror:8 row_mask:0xf bank_mask:0xf
v_mov_b32 v90, v80
v_mov_b32 v91, v81
v_mov_b32 v92, v82
v_mov_b32 v93, v83
v_mov_b32 v94, v84
v_mov_b32 v95, v85
v_mov_b32 v96, v86
v_mov_b32 v97, v87
v_permlane16_swap_b32 v90, v80
v_permlane16_swap_b32 v91, v81
v_permlane16_swap_b32 v92, v82
v_permlane16_swap_b32 v93, v83
v_permlane16_swap_b32 v94, v84
v_permlane16_swap_b32 v95, v85
v_permlane16_swap_b32 v96, v86
v_permlane16_swap_b32 v97, v87
v_add_f32 v80, v80, v90
v_add_f32 v81, v81, v91
v_add_f32 v82, v82, v92
v_add_f32 v83, v83, v93
v_add_f32 v84, v84, v94
v_add_f32 v85, v85, v95
v_add_f32 v86, v86, v96
v_add_f32 v87, v87, v97
v_mov_b32 v90, v80
v_mov_b32 v91, v81
v_mov_b32 v92, v82
v_mov_b32 v93, v83
v_mov_b32 v94, v84
v_mov_b32 v95, v85
v_mov_b32 v96, v86
v_mov_b32 v97, v87
v_permlane32_swap_b32 v90, v80
v_permlane32_swap_b32 v91, v81
v_permlane32_swap_b32 v92, v82
v_permlane32_swap_b32 v93, v83
v_permlane32_swap_b32 v94, v84
v_permlane32_swap_b32 v95, v85
v_permlane32_swap_b32 v96, v86
v_permlane32_swap_b32 v97, v87
v_add_f32 v80, v80, v90
v_add_f32 v81, v81, v91
v_add_f32 v82, v82, v92
v_add_f32 v83, v83, v93
v_add_f32 v84, v84, v94
v_add_f32 v85, v85, v95
v_add_f32 v86, v86, v96
v_add_f32 v87, v87, v97
v_lshlrev_b32 v9, 7, v7
v_lshl_add_u32 v9, v8, 6, v9
s_mul_i32 s3, s27, 13824
s_lshl_b32 s4, s25, 5
s_add_u32 s3, s3, s4
s_add_u32 s3, s3, 41943040
v_cmp_eq_u32 vcc, 0, v5
s_nop 3
s_and_saveexec_b64 s[6:7], vcc
buffer_store_dwordx4 v[80:83], v9, s[8:11], s3 offen
buffer_store_dwordx4 v[84:87], v9, s[8:11], s3 offen offset:16
s_mov_b64 exec, s[6:7]
s_branch l1_kernel_pf_done
l1_kernel_pf_wd:
s_lshl_b32 s3, s26, 6
v_lshl_add_u32 v7, v5, 3, s3
s_lshl_b32 s3, s25, 6
v_lshl_add_u32 v3, v4, 3, s3
v_lshrrev_b32 v6, 5, v7
v_mul_u32_u24 v6, 5120, v6
v_bfe_u32 v8, v7, 3, 2
v_lshl_add_u32 v6, v8, 8, v6
s_mov_b32 s28, 52429
v_add_u32 v8, 0, v3
v_sub_u32 v9, 960, v8
v_cmp_lt_u32 vcc, 320, v8
s_nop 1
v_cndmask_b32 v8, v8, v9, vcc
v_mul_u32_u24 v9, s28, v8
v_lshrrev_b32 v9, 22, v9
v_mul_u32_u24 v10, 80, v9
v_sub_u32 v8, v8, v10
v_mul_u32_u24 v9, 276480, v9
v_add_u32 v9, v9, v6
v_lshrrev_b32 v10, 5, v8
v_lshlrev_b32 v10, 1, v10
v_bfe_u32 v11, v8, 2, 1
v_add_u32 v10, v10, v11
v_bfe_u32 v11, v8, 3, 2
v_lshlrev_b32 v11, 2, v11
v_and_b32 v12, 3, v8
v_add_u32 v11, v11, v12
v_and_b32 v12, 15, v8
v_cmp_le_u32 vcc, 64, v8
s_nop 1
v_cndmask_b32 v10, v10, 4, vcc
v_cndmask_b32 v11, v11, v12, vcc
v_lshl_add_u32 v9, v10, 10, v9
v_lshl_add_u32 v100, v11, 4, v9
v_add_u32 v8, 1, v3
v_sub_u32 v9, 960, v8
v_cmp_lt_u32 vcc, 320, v8
s_nop 1
v_cndmask_b32 v8, v8, v9, vcc
v_mul_u32_u24 v9, s28, v8
v_lshrrev_b32 v9, 22, v9
v_mul_u32_u24 v10, 80, v9
v_sub_u32 v8, v8, v10
v_mul_u32_u24 v9, 276480, v9
v_add_u32 v9, v9, v6
v_lshrrev_b32 v10, 5, v8
v_lshlrev_b32 v10, 1, v10
v_bfe_u32 v11, v8, 2, 1
v_add_u32 v10, v10, v11
v_bfe_u32 v11, v8, 3, 2
v_lshlrev_b32 v11, 2, v11
v_and_b32 v12, 3, v8
v_add_u32 v11, v11, v12
v_and_b32 v12, 15, v8
v_cmp_le_u32 vcc, 64, v8
s_nop 1
v_cndmask_b32 v10, v10, 4, vcc
v_cndmask_b32 v11, v11, v12, vcc
v_lshl_add_u32 v9, v10, 10, v9
v_lshl_add_u32 v101, v11, 4, v9
v_add_u32 v8, 2, v3
v_sub_u32 v9, 960, v8
v_cmp_lt_u32 vcc, 320, v8
s_nop 1
v_cndmask_b32 v8, v8, v9, vcc
v_mul_u32_u24 v9, s28, v8
v_lshrrev_b32 v9, 22, v9
v_mul_u32_u24 v10, 80, v9
v_sub_u32 v8, v8, v10
v_mul_u32_u24 v9, 276480, v9
v_add_u32 v9, v9, v6
v_lshrrev_b32 v10, 5, v8
v_lshlrev_b32 v10, 1, v10
v_bfe_u32 v11, v8, 2, 1
v_add_u32 v10, v10, v11
v_bfe_u32 v11, v8, 3, 2
v_lshlrev_b32 v11, 2, v11
v_and_b32 v12, 3, v8
v_add_u32 v11, v11, v12
v_and_b32 v12, 15, v8
v_cmp_le_u32 vcc, 64, v8
s_nop 1
v_cndmask_b32 v10, v10, 4, vcc
v_cndmask_b32 v11, v11, v12, vcc
v_lshl_add_u32 v9, v10, 10, v9
v_lshl_add_u32 v102, v11, 4, v9
v_add_u32 v8, 3, v3
v_sub_u32 v9, 960, v8
v_cmp_lt_u32 vcc, 320, v8
s_nop 1
v_cndmask_b32 v8, v8, v9, vcc
v_mul_u32_u24 v9, s28, v8
v_lshrrev_b32 v9, 22, v9
v_mul_u32_u24 v10, 80, v9
v_sub_u32 v8, v8, v10
v_mul_u32_u24 v9, 276480, v9
v_add_u32 v9, v9, v6
v_lshrrev_b32 v10, 5, v8
v_lshlrev_b32 v10, 1, v10
v_bfe_u32 v11, v8, 2, 1
v_add_u32 v10, v10, v11
v_bfe_u32 v11, v8, 3, 2
v_lshlrev_b32 v11, 2, v11
v_and_b32 v12, 3, v8
v_add_u32 v11, v11, v12
v_and_b32 v12, 15, v8
v_cmp_le_u32 vcc, 64, v8
s_nop 1
v_cndmask_b32 v10, v10, 4, vcc
v_cndmask_b32 v11, v11, v12, vcc
v_lshl_add_u32 v9, v10, 10, v9
v_lshl_add_u32 v103, v11, 4, v9
v_add_u32 v8, 4, v3
v_sub_u32 v9, 960, v8
v_cmp_lt_u32 vcc, 320, v8
s_nop 1
v_cndmask_b32 v8, v8, v9, vcc
v_mul_u32_u24 v9, s28, v8
v_lshrrev_b32 v9, 22, v9
v_mul_u32_u24 v10, 80, v9
v_sub_u32 v8, v8, v10
v_mul_u32_u24 v9, 276480, v9
v_add_u32 v9, v9, v6
v_lshrrev_b32 v10, 5, v8
v_lshlrev_b32 v10, 1, v10
v_bfe_u32 v11, v8, 2, 1
v_add_u32 v10, v10, v11
v_bfe_u32 v11, v8, 3, 2
v_lshlrev_b32 v11, 2, v11
v_and_b32 v12, 3, v8
v_add_u32 v11, v11, v12
v_and_b32 v12, 15, v8
v_cmp_le_u32 vcc, 64, v8
s_nop 1
v_cndmask_b32 v10, v10, 4, vcc
v_cndmask_b32 v11, v11, v12, vcc
v_lshl_add_u32 v9, v10, 10, v9
v_lshl_add_u32 v104, v11, 4, v9
v_add_u32 v8, 5, v3
v_sub_u32 v9, 960, v8
v_cmp_lt_u32 vcc, 320, v8
s_nop 1
v_cndmask_b32 v8, v8, v9, vcc
v_mul_u32_u24 v9, s28, v8
v_lshrrev_b32 v9, 22, v9
v_mul_u32_u24 v10, 80, v9
v_sub_u32 v8, v8, v10
v_mul_u32_u24 v9, 276480, v9
v_add_u32 v9, v9, v6
v_lshrrev_b32 v10, 5, v8
v_lshlrev_b32 v10, 1, v10
v_bfe_u32 v11, v8, 2, 1
v_add_u32 v10, v10, v11
v_bfe_u32 v11, v8, 3, 2
v_lshlrev_b32 v11, 2, v11
v_and_b32 v12, 3, v8
v_add_u32 v11, v11, v12
v_and_b32 v12, 15, v8
v_cmp_le_u32 vcc, 64, v8
s_nop 1
v_cndmask_b32 v10, v10, 4, vcc
v_cndmask_b32 v11, v11, v12, vcc
v_lshl_add_u32 v9, v10, 10, v9
v_lshl_add_u32 v105, v11, 4, v9
v_add_u32 v8, 6, v3
v_sub_u32 v9, 960, v8
v_cmp_lt_u32 vcc, 320, v8
s_nop 1
v_cndmask_b32 v8, v8, v9, vcc
v_mul_u32_u24 v9, s28, v8
v_lshrrev_b32 v9, 22, v9
v_mul_u32_u24 v10, 80, v9
v_sub_u32 v8, v8, v10
v_mul_u32_u24 v9, 276480, v9
v_add_u32 v9, v9, v6
v_lshrrev_b32 v10, 5, v8
v_lshlrev_b32 v10, 1, v10
v_bfe_u32 v11, v8, 2, 1
v_add_u32 v10, v10, v11
v_bfe_u32 v11, v8, 3, 2
v_lshlrev_b32 v11, 2, v11
v_and_b32 v12, 3, v8
v_add_u32 v11, v11, v12
v_and_b32 v12, 15, v8
v_cmp_le_u32 vcc, 64, v8
s_nop 1
v_cndmask_b32 v10, v10, 4, vcc
v_cndmask_b32 v11, v11, v12, vcc
v_lshl_add_u32 v9, v10, 10, v9
v_lshl_add_u32 v106, v11, 4, v9
v_add_u32 v8, 7, v3
v_sub_u32 v9, 960, v8
v_cmp_lt_u32 vcc, 320, v8
s_nop 1
v_cndmask_b32 v8, v8, v9, vcc
v_mul_u32_u24 v9, s28, v8
v_lshrrev_b32 v9, 22, v9
v_mul_u32_u24 v10, 80, v9
v_sub_u32 v8, v8, v10
v_mul_u32_u24 v9, 276480, v9
v_add_u32 v9, v9, v6
v_lshrrev_b32 v10, 5, v8
v_lshlrev_b32 v10, 1, v10
v_bfe_u32 v11, v8, 2, 1
v_add_u32 v10, v10, v11
v_bfe_u32 v11, v8, 3, 2
v_lshlrev_b32 v11, 2, v11
v_and_b32 v12, 3, v8
v_add_u32 v11, v11, v12
v_and_b32 v12, 15, v8
v_cmp_le_u32 vcc, 64, v8
s_nop 1
v_cndmask_b32 v10, v10, 4, vcc
v_cndmask_b32 v11, v11, v12, vcc
v_lshl_add_u32 v9, v10, 10, v9
v_lshl_add_u32 v107, v11, 4, v9
s_mov_b32 s3, 38797312
buffer_store_dwordx4 v[48:51], v100, s[8:11], s3 offen
buffer_store_dwordx4 v[52:55], v101, s[8:11], s3 offen
buffer_store_dwordx4 v[56:59], v102, s[8:11], s3 offen
buffer_store_dwordx4 v[60:63], v103, s[8:11], s3 offen
buffer_store_dwordx4 v[64:67], v104, s[8:11], s3 offen
buffer_store_dwordx4 v[68:71], v105, s[8:11], s3 offen
buffer_store_dwordx4 v[72:75], v106, s[8:11], s3 offen
buffer_store_dwordx4 v[76:79], v107, s[8:11], s3 offen
l1_kernel_pf_done:
s_getpc_b64 s[50:51]
l2_kernel_pc2_3408_2077:
s_add_u32 s50, s50, l2_kernel-l2_kernel_pc2_3408_2077
s_addc_u32 s51, s51, 0
v_lshlrev_b32 v2, 4, v0
v_min_u32 v3, l2_kernel_end-l2_kernel-16, v2
global_load_dwordx4 v[244:247], v3, s[50:51]
v_add_u32 v2, 4096, v2
v_min_u32 v3, l2_kernel_end-l2_kernel-16, v2
global_load_dwordx4 v[244:247], v3, s[50:51]
v_add_u32 v2, 4096, v2
v_min_u32 v3, l2_kernel_end-l2_kernel-16, v2
global_load_dwordx4 v[244:247], v3, s[50:51]
v_add_u32 v2, 4096, v2
v_min_u32 v3, l2_kernel_end-l2_kernel-16, v2
global_load_dwordx4 v[244:247], v3, s[50:51]
v_add_u32 v2, 4096, v2
v_min_u32 v3, l2_kernel_end-l2_kernel-16, v2
global_load_dwordx4 v[244:247], v3, s[50:51]
v_add_u32 v2, 4096, v2
v_min_u32 v3, l2_kernel_end-l2_kernel-16, v2
global_load_dwordx4 v[244:247], v3, s[50:51]
v_add_u32 v2, 4096, v2
v_min_u32 v3, l2_kernel_end-l2_kernel-16, v2
global_load_dwordx4 v[244:247], v3, s[50:51]
v_add_u32 v2, 4096, v2
s_cmp_lg_u32 s33, 811
s_cbranch_scc1 l1_kernel_nz
v_and_b32 v1, 63, v0
v_lshlrev_b32 v1, 4, v1
v_mov_b32 v4, 0
v_mov_b32 v5, 0
v_mov_b32 v6, 0
v_mov_b32 v7, 0
s_mov_b32 s3, 43515904
s_mov_b32 s4, 0
l1_kernel_zl:
buffer_store_dwordx4 v[4:7], v1, s[8:11], s3 offen
s_add_u32 s3, s3, 1024
s_add_u32 s4, s4, 1
s_cmp_lt_u32 s4, 40
s_cbranch_scc1 l1_kernel_zl
l1_kernel_nz:
l1_kernel_end:
s_endpgm
.section .rodata,"a"
.p2align 6
.amdhsa_kernel l1_kernel
  .amdhsa_next_free_vgpr 256
  .amdhsa_next_free_sgpr 100
  .amdhsa_accum_offset 256
  .amdhsa_group_segment_fixed_size 0
  .amdhsa_kernarg_size 96
  .amdhsa_user_sgpr_count 2
  .amdhsa_user_sgpr_kernarg_segment_ptr 1
  .amdhsa_system_sgpr_workgroup_id_x 1
.end_amdhsa_kernel

.text
.globl l2_kernel
.p2align 8
.type l2_kernel,@function
l2_kernel:
s_cmp_ge_u32 s2, 256
s_cbranch_scc1 l2_kernel_end
s_getpc_b64 s[50:51]
l2_kernel_pc2_2288_2:
s_sub_u32 s50, s50, l2_kernel_pc2_2288_2-l2_kernel
s_subb_u32 s51, s51, 0
v_lshlrev_b32 v2, 4, v0
v_min_u32 v3, l2_kernel_end-l2_kernel-16, v2
global_load_dwordx4 v[124:127], v3, s[50:51]
v_add_u32 v2, 4096, v2
v_min_u32 v3, l2_kernel_end-l2_kernel-16, v2
global_load_dwordx4 v[124:127], v3, s[50:51]
v_add_u32 v2, 4096, v2
v_min_u32 v3, l2_kernel_end-l2_kernel-16, v2
global_load_dwordx4 v[124:127], v3, s[50:51]
v_add_u32 v2, 4096, v2
v_min_u32 v3, l2_kernel_end-l2_kernel-16, v2
global_load_dwordx4 v[124:127], v3, s[50:51]
v_add_u32 v2, 4096, v2
v_min_u32 v3, l2_kernel_end-l2_kernel-16, v2
global_load_dwordx4 v[124:127], v3, s[50:51]
v_add_u32 v2, 4096, v2
v_min_u32 v3, l2_kernel_end-l2_kernel-16, v2
global_load_dwordx4 v[124:127], v3, s[50:51]
v_add_u32 v2, 4096, v2
v_min_u32 v3, l2_kernel_end-l2_kernel-16, v2
global_load_dwordx4 v[124:127], v3, s[50:51]
v_add_u32 v2, 4096, v2
s_load_dwordx2 s[4:5], s[0:1], 88
s_load_dwordx2 s[100:101], s[0:1], 72
v_lshrrev_b32 v1, 6, v0
s_nop 0
v_readfirstlane_b32 s20, v1
s_and_b32 s3, s2, 7
s_lshr_b32 s24, s2, 3
s_lshr_b32 s21, s3, 1
s_lshl_b32 s21, s21, 2
s_lshr_b32 s25, s24, 3
s_add_u32 s21, s21, s25
s_and_b32 s22, s3, 1
s_lshl_b32 s22, s22, 3
s_and_b32 s25, s24, 7
s_add_u32 s22, s22, s25
s_mov_b32 s78, s22
s_mov_b32 s67, 0
s_mov_b32 s76, 0
s_waitcnt lgkmcnt(0)
s_mov_b32 s8, s4
s_mov_b32 s9, s5
s_mov_b32 s10, 268435456
s_mov_b32 s11, 0x20000
l2_kernel_layer:
s_mul_i32 s68, s67, 3145728
s_mul_i32 s69, s67, 6291456
s_mul_i32 s74, s67, 7340032
s_mul_i32 s75, s67, 393216
s_lshl_b32 s3, s21, 8
s_lshl_b32 s4, s67, 14
s_add_u32 s3, s3, s4
s_add_u32 s80, s3, 43515904
s_add_u32 s81, s3, 43520000
s_add_u32 s82, s3, 43524096
s_add_u32 s83, s3, 43528192
v_and_b32 v4, 63, v0
v_lshlrev_b32 v1, 4, v4
v_mov_b32 v5, 0
v_mov_b32 v6, 0
s_cmp_ge_u32 s78, 10
s_cbranch_scc1 l2_kernel_nof2a
s_cmp_ge_u32 s78, 5
s_cselect_b32 s3, 2, 0
s_cselect_b32 s4, 5, 0
s_sub_u32 s30, s78, s4
s_lshl_b32 s27, s21, 2
s_add_u32 s27, s27, s3
s_lshr_b32 s4, s27, 2
s_sub_u32 s5, 16, s4
s_and_b32 s5, s5, 15
s_bitcmp1_b32 s27, 1
s_cselect_b32 s4, s5, s4
s_and_b32 s5, s27, 1
s_lshl_b32 s5, s5, 5
s_add_u32 s4, s4, s5
s_and_b32 s5, s27, 2
s_lshl_b32 s5, s5, 3
s_add_u32 s24, s4, s5
s_and_b32 s26, s20, 1
s_lshr_b32 s25, s20, 1
s_lshl_b32 s3, s30, 1
s_add_u32 s25, s25, s3
s_add_u32 s27, s27, s26
s_lshl_b32 s3, s26, 5
s_add_u32 s29, s24, s3
s_sub_u32 s31, 64, s29
s_and_b32 s31, s31, 63
s_and_b32 s4, s31, 15
s_sub_u32 s5, 16, s4
s_and_b32 s5, s5, 15
s_bitcmp1_b32 s31, 4
s_cselect_b32 s4, s5, s4
s_lshl_b32 s4, s4, 2
s_lshr_b32 s5, s31, 5
s_add_u32 s4, s4, s5
s_lshr_b32 s5, s31, 3
s_and_b32 s5, s5, 2
s_add_u32 s28, s4, s5
v_and_b32 v4, 63, v0
v_lshlrev_b32 v1, 4, v4
v_and_b32 v2, 31, v0
v_bfe_u32 v3, v0, 5, 1
s_lshl_b32 s4, s30, 2
s_add_u32 s3, s4, s20
s_lshl_b32 s3, s3, 11
s_lshl_b32 s4, s24, 6
s_add_u32 s3, s3, s4
s_add_u32 s3, s3, 12582912
s_add_u32 s3, s3, s68
v_bfe_u32 v7, v0, 2, 4
v_mul_u32_u24 v7, 40960, v7
v_and_b32 v8, 3, v0
v_lshl_add_u32 v7, v8, 4, v7
s_mul_i32 s4, s20, 4224
s_add_u32 m0, s4, 122880
s_nop 0
buffer_load_dwordx4 v7, s[8:11], s3 offen sc1 lds
s_add_u32 s3, s3, 655360
s_add_u32 m0, m0, 1024
s_nop 0
buffer_load_dwordx4 v7, s[8:11], s3 offen sc1 lds
s_add_u32 s3, s3, 655360
s_add_u32 m0, m0, 1024
s_nop 0
buffer_load_dwordx4 v7, s[8:11], s3 offen sc1 lds
s_add_u32 s3, s3, 655360
s_add_u32 m0, m0, 1024
s_nop 0
buffer_load_dwordx4 v7, s[8:11], s3 offen sc1 lds
s_mul_i32 s3, s27, 40960
s_lshl_b32 s5, s25, 11
s_add_u32 s3, s3, s5
s_add_u32 s32, s3, 0
s_add_u32 s32, s32, s69
s_mul_i32 s4, s28, 40960
s_add_u32 s4, s4, s5
s_add_u32 s33, s4, 20480
s_add_u32 s33, s33, s69
s_cmp_eq_u32 s29, 0
s_cselect_b32 s6, 32, 31
v_sub_u32 v5, s6, v2
v_and_b32 v5, 31, v5
v_lshlrev_b32 v6, 9, v3
v_lshl_add_u32 v6, v5, 4, v6
buffer_load_dwordx4 v[112:115], v1, s[8:11], s32 offen offset:0 sc1
buffer_load_dwordx4 v[116:119], v1, s[8:11], s32 offen offset:1024 sc1
buffer_load_dwordx4 v[120:123], v6, s[8:11], s33 offen offset:0 sc1
buffer_load_dwordx4 v[124:127], v6, s[8:11], s33 offen offset:1024 sc1
l2_kernel_nof2a:
s_mul_i32 s34, s20, 5120
s_mul_i32 s79, s22, 27
s_lshr_b32 s79, s79, 2
s_add_u32 s4, s22, 1
s_mul_i32 s4, s4, 27
s_lshr_b32 s4, s4, 2
s_sub_u32 s37, s4, s79
s_mul_i32 s35, s79, 40960
s_add_u32 s35, s35, 33554432
s_lshl_b32 s5, s21, 2
s_add_u32 s5, s5, s20
s_mul_i32 s36, s5, 110592
s_lshl_b32 s4, s79, 9
s_add_u32 s36, s36, s4
s_add_u32 s36, s36, 18874368
s_add_u32 s36, s36, s74
s_mul_i32 s38, s5, 40960
s_add_u32 s38, s38, 3145728
s_add_u32 s38, s38, s69
s_mul_i32 s39, s5, 5120
s_add_u32 s39, s39, 42205184
s_add_u32 s39, s39, s75
v_and_b32 v10, 63, v0
v_lshlrev_b32 v1, 4, v10
s_and_b32 s23, s22, 7
s_lshr_b32 s24, s22, 3
s_mul_i32 s54, s23, 276480
s_add_u32 s54, s54, 38797312
s_add_u32 s55, s54, 4096
s_lshl_b32 s5, s21, 3
s_lshl_b32 s6, s24, 2
s_add_u32 s5, s5, s6
s_add_u32 s3, s20, 0
s_and_b32 s3, s3, 3
s_add_u32 s3, s3, s5
s_mul_i32 s3, s3, 55296
s_add_u32 s56, s3, 18874368
s_add_u32 s56, s56, s74
s_add_u32 s3, s20, 1
s_and_b32 s3, s3, 3
s_add_u32 s3, s3, s5
s_mul_i32 s3, s3, 55296
s_add_u32 s57, s3, 18874368
s_add_u32 s57, s57, s74
s_add_u32 s3, s20, 2
s_and_b32 s3, s3, 3
s_add_u32 s3, s3, s5
s_mul_i32 s3, s3, 55296
s_add_u32 s58, s3, 18874368
s_add_u32 s58, s58, s74
s_add_u32 s3, s20, 3
s_and_b32 s3, s3, 3
s_add_u32 s3, s3, s5
s_mul_i32 s3, s3, 55296
s_add_u32 s59, s3, 18874368
s_add_u32 s59, s59, s74
s_mov_b32 s3, 577573312
s_cmp_eq_u32 s20, 1
s_cselect_b32 s3, 628179585, s3
s_cmp_eq_u32 s20, 2
s_cselect_b32 s3, 645485251, s3
s_cmp_eq_u32 s20, 3
s_cselect_b32 s3, 696091524, s3
s_bfe_u32 s40, s3, 0x60000
s_bfe_u32 s41, s3, 0x60006
s_bfe_u32 s42, s3, 0x6000c
s_bfe_u32 s43, s3, 0x60012
s_bfe_u32 s44, s3, 0x60018
s_mov_b32 s3, 831332716
s_cmp_eq_u32 s20, 1
s_cselect_b32 s3, 882729519, s3
s_cmp_eq_u32 s20, 2
s_cselect_b32 s3, 162108208, s3
s_cmp_eq_u32 s20, 3
s_cselect_b32 s3, 230032371, s3
s_bfe_u32 s45, s3, 0x60000
s_bfe_u32 s46, s3, 0x60006
s_bfe_u32 s47, s3, 0x6000c
s_bfe_u32 s48, s3, 0x60012
s_bfe_u32 s49, s3, 0x60018
s_mov_b32 s3, 11392002
s_cmp_eq_u32 s20, 1
s_cselect_b32 s3, 12195014, s3
s_cmp_eq_u32 s20, 2
s_cselect_b32 s3, 13314327, s3
s_cmp_eq_u32 s20, 3
s_cselect_b32 s3, 14113306, s3
s_bfe_u32 s50, s3, 0x60000
s_bfe_u32 s51, s3, 0x60006
s_bfe_u32 s52, s3, 0x6000c
s_bfe_u32 s53, s3, 0x60012
s_lshl_b32 s5, s21, 2
s_lshl_b32 s6, s24, 1
s_add_u32 s5, s5, s6
s_lshr_b32 s6, s20, 1
s_add_u32 s66, s5, s6
s_mul_i32 s3, s66, 40960
s_mul_i32 s4, s23, 5120
s_add_u32 s3, s3, s4
s_add_u32 s60, s3, 3145728
s_add_u32 s60, s60, s69
s_add_u32 s61, s60, 4096
s_add_u32 s62, s3, 6291456
s_add_u32 s63, s62, 4096
s_lshl_b32 s3, s66, 11
s_lshl_b32 s4, s23, 8
s_add_u32 s3, s3, s4
s_add_u32 s64, s3, 42991616
s_lshr_b32 s3, s66, 2
s_sub_u32 s4, 16, s3
s_and_b32 s4, s4, 15
s_bitcmp1_b32 s66, 1
s_cselect_b32 s3, s4, s3
s_and_b32 s4, s66, 1
s_lshl_b32 s4, s4, 5
s_add_u32 s3, s3, s4
s_and_b32 s4, s66, 2
s_lshl_b32 s4, s4, 3
s_add_u32 s65, s3, s4
s_lshl_b32 s70, s21, 2
s_lshr_b32 s3, s22, 2
s_add_u32 s70, s70, s3
s_and_b32 s71, s22, 3
s_lshr_b32 s3, s70, 2
s_sub_u32 s4, 16, s3
s_and_b32 s4, s4, 15
s_bitcmp1_b32 s70, 1
s_cselect_b32 s3, s4, s3
s_and_b32 s4, s70, 1
s_lshl_b32 s4, s4, 5
s_add_u32 s3, s3, s4
s_and_b32 s4, s70, 2
s_lshl_b32 s4, s4, 3
s_add_u32 s72, s3, s4
s_cmp_ge_u32 s78, 10
s_cbranch_scc1 l2_kernel_nof2b
v_lshlrev_b32 v7, 1, v2
v_add_u32 v7, s26, v7
v_cvt_f32_u32 v7, v7
v_mul_f32 v7, 0x3c800000, v7
v_cvt_f32_u32 v8, v3
v_mul_f32 v8, 4.0, v8
v_mul_f32 v8, v8, v7
s_mov_b32 s3, 0x0
v_fma_f32 v9, s3, v7, v8
v_cos_f32 v10, v9
v_sin_f32 v11, v9
s_nop 0
v_cvt_pk_f16_f32 v32, v10, v11
s_mov_b32 s3, 0x3f800000
v_fma_f32 v12, s3, v7, v8
v_cos_f32 v13, v12
v_sin_f32 v14, v12
s_nop 0
v_cvt_pk_f16_f32 v33, v13, v14
s_mov_b32 s3, 0x40000000
v_fma_f32 v9, s3, v7, v8
v_cos_f32 v10, v9
v_sin_f32 v11, v9
s_nop 0
v_cvt_pk_f16_f32 v34, v10, v11
s_mov_b32 s3, 0x40400000
v_fma_f32 v12, s3, v7, v8
v_cos_f32 v13, v12
v_sin_f32 v14, v12
s_nop 0
v_cvt_pk_f16_f32 v35, v13, v14
s_mov_b32 s3, 0x41000000
v_fma_f32 v9, s3, v7, v8
v_cos_f32 v10, v9
v_sin_f32 v11, v9
s_nop 0
v_cvt_pk_f16_f32 v36, v10, v11
s_mov_b32 s3, 0x41100000
v_fma_f32 v12, s3, v7, v8
v_cos_f32 v13, v12
v_sin_f32 v14, v12
s_nop 0
v_cvt_pk_f16_f32 v37, v13, v14
s_mov_b32 s3, 0x41200000
v_fma_f32 v9, s3, v7, v8
v_cos_f32 v10, v9
v_sin_f32 v11, v9
s_nop 0
v_cvt_pk_f16_f32 v38, v10, v11
s_mov_b32 s3, 0x41300000
v_fma_f32 v12, s3, v7, v8
v_cos_f32 v13, v12
v_sin_f32 v14, v12
s_nop 0
v_cvt_pk_f16_f32 v39, v13, v14
s_mov_b32 s3, 0x41800000
v_fma_f32 v9, s3, v7, v8
v_cos_f32 v10, v9
v_sin_f32 v11, v9
s_nop 0
v_cvt_pk_f16_f32 v40, v10, v11
s_mov_b32 s3, 0x41880000
v_fma_f32 v12, s3, v7, v8
v_cos_f32 v13, v12
v_sin_f32 v14, v12
s_nop 0
v_cvt_pk_f16_f32 v41, v13, v14
s_mov_b32 s3, 0x41900000
v_fma_f32 v9, s3, v7, v8
v_cos_f32 v10, v9
v_sin_f32 v11, v9
s_nop 0
v_cvt_pk_f16_f32 v42, v10, v11
s_mov_b32 s3, 0x41980000
v_fma_f32 v12, s3, v7, v8
v_cos_f32 v13, v12
v_sin_f32 v14, v12
s_nop 0
v_cvt_pk_f16_f32 v43, v13, v14
s_mov_b32 s3, 0x41c00000
v_fma_f32 v9, s3, v7, v8
v_cos_f32 v10, v9
v_sin_f32 v11, v9
s_nop 0
v_cvt_pk_f16_f32 v44, v10, v11
s_mov_b32 s3, 0x41c80000
v_fma_f32 v12, s3, v7, v8
v_cos_f32 v13, v12
v_sin_f32 v14, v12
s_nop 0
v_cvt_pk_f16_f32 v45, v13, v14
s_mov_b32 s3, 0x41d00000
v_fma_f32 v9, s3, v7, v8
v_cos_f32 v10, v9
v_sin_f32 v11, v9
s_nop 0
v_cvt_pk_f16_f32 v46, v10, v11
s_mov_b32 s3, 0x41d80000
v_fma_f32 v12, s3, v7, v8
v_cos_f32 v13, v12
v_sin_f32 v14, v12
s_nop 0
v_cvt_pk_f16_f32 v47, v13, v14
s_mov_b32 s3, 0x42000000
v_fma_f32 v9, s3, v7, v8
v_cos_f32 v10, v9
v_sin_f32 v11, v9
s_nop 0
v_cvt_pk_f16_f32 v48, v10, v11
s_mov_b32 s3, 0x42040000
v_fma_f32 v12, s3, v7, v8
v_cos_f32 v13, v12
v_sin_f32 v14, v12
s_nop 0
v_cvt_pk_f16_f32 v49, v13, v14
s_mov_b32 s3, 0x42080000
v_fma_f32 v9, s3, v7, v8
v_cos_f32 v10, v9
v_sin_f32 v11, v9
s_nop 0
v_cvt_pk_f16_f32 v50, v10, v11
s_mov_b32 s3, 0x420c0000
v_fma_f32 v12, s3, v7, v8
v_cos_f32 v13, v12
v_sin_f32 v14, v12
s_nop 0
v_cvt_pk_f16_f32 v51, v13, v14
s_mov_b32 s3, 0x42200000
v_fma_f32 v9, s3, v7, v8
v_cos_f32 v10, v9
v_sin_f32 v11, v9
s_nop 0
v_cvt_pk_f16_f32 v52, v10, v11
s_mov_b32 s3, 0x42240000
v_fma_f32 v12, s3, v7, v8
v_cos_f32 v13, v12
v_sin_f32 v14, v12
s_nop 0
v_cvt_pk_f16_f32 v53, v13, v14
s_mov_b32 s3, 0x42280000
v_fma_f32 v9, s3, v7, v8
v_cos_f32 v10, v9
v_sin_f32 v11, v9
s_nop 0
v_cvt_pk_f16_f32 v54, v10, v11
s_mov_b32 s3, 0x422c0000
v_fma_f32 v12, s3, v7, v8
v_cos_f32 v13, v12
v_sin_f32 v14, v12
s_nop 0
v_cvt_pk_f16_f32 v55, v13, v14
s_mov_b32 s3, 0x42400000
v_fma_f32 v9, s3, v7, v8
v_cos_f32 v10, v9
v_sin_f32 v11, v9
s_nop 0
v_cvt_pk_f16_f32 v56, v10, v11
s_mov_b32 s3, 0x42440000
v_fma_f32 v12, s3, v7, v8
v_cos_f32 v13, v12
v_sin_f32 v14, v12
s_nop 0
v_cvt_pk_f16_f32 v57, v13, v14
s_mov_b32 s3, 0x42480000
v_fma_f32 v9, s3, v7, v8
v_cos_f32 v10, v9
v_sin_f32 v11, v9
s_nop 0
v_cvt_pk_f16_f32 v58, v10, v11
s_mov_b32 s3, 0x424c0000
v_fma_f32 v12, s3, v7, v8
v_cos_f32 v13, v12
v_sin_f32 v14, v12
s_nop 0
v_cvt_pk_f16_f32 v59, v13, v14
s_mov_b32 s3, 0x42600000
v_fma_f32 v9, s3, v7, v8
v_cos_f32 v10, v9
v_sin_f32 v11, v9
s_nop 0
v_cvt_pk_f16_f32 v60, v10, v11
s_mov_b32 s3, 0x42640000
v_fma_f32 v12, s3, v7, v8
v_cos_f32 v13, v12
v_sin_f32 v14, v12
s_nop 0
v_cvt_pk_f16_f32 v61, v13, v14
s_mov_b32 s3, 0x42680000
v_fma_f32 v9, s3, v7, v8
v_cos_f32 v10, v9
v_sin_f32 v11, v9
s_nop 0
v_cvt_pk_f16_f32 v62, v10, v11
s_mov_b32 s3, 0x426c0000
v_fma_f32 v12, s3, v7, v8
v_cos_f32 v13, v12
v_sin_f32 v14, v12
s_nop 0
v_cvt_pk_f16_f32 v63, v13, v14
s_lshr_b32 s3, s20, 1
s_mul_i32 s3, s3, 8448
s_add_u32 s3, s3, 122880
v_bfe_u32 v9, v0, 4, 1
v_mul_u32_u24 v9, 4224, v9
v_lshl_add_u32 v9, v3, 8, v9
v_and_b32 v10, 15, v0
v_lshl_add_u32 v9, v10, 3, v9
v_add_u32 v9, s3, v9
s_waitcnt vmcnt(4)
s_barrier
ds_read_b64_tr_b16 v[64:65], v9 offset:0
ds_read_b64_tr_b16 v[66:67], v9 offset:128
ds_read_b64_tr_b16 v[68:69], v9 offset:512
ds_read_b64_tr_b16 v[70:71], v9 offset:640
ds_read_b64_tr_b16 v[72:73], v9 offset:1024
ds_read_b64_tr_b16 v[74:75], v9 offset:1152
ds_read_b64_tr_b16 v[76:77], v9 offset:1536
ds_read_b64_tr_b16 v[78:79], v9 offset:1664
ds_read_b64_tr_b16 v[80:81], v9 offset:2048
ds_read_b64_tr_b16 v[82:83], v9 offset:2176
s_waitcnt lgkmcnt(8)
v_mfma_f32_32x32x16_f16 v[96:111], v[64:67], v[32:35], 0
ds_read_b64_tr_b16 v[84:85], v9 offset:2560
ds_read_b64_tr_b16 v[86:87], v9 offset:2688
s_waitcnt lgkmcnt(8)
v_mfma_f32_32x32x16_f16 v[96:111], v[68:71], v[36:39], v[96:111]
ds_read_b64_tr_b16 v[88:89], v9 offset:3072
ds_read_b64_tr_b16 v[90:91], v9 offset:3200
s_waitcnt lgkmcnt(8)
v_mfma_f32_32x32x16_f16 v[96:111], v[72:75], v[40:43], v[96:111]
ds_read_b64_tr_b16 v[92:93], v9 offset:3584
ds_read_b64_tr_b16 v[94:95], v9 offset:3712
s_waitcnt lgkmcnt(8)
v_mfma_f32_32x32x16_f16 v[96:111], v[76:79], v[44:47], v[96:111]
s_waitcnt lgkmcnt(6)
v_mfma_f32_32x32x16_f16 v[96:111], v[80:83], v[48:51], v[96:111]
s_waitcnt lgkmcnt(4)
v_mfma_f32_32x32x16_f16 v[96:111], v[84:87], v[52:55], v[96:111]
s_waitcnt lgkmcnt(2)
v_mfma_f32_32x32x16_f16 v[96:111], v[88:91], v[56:59], v[96:111]
s_waitcnt lgkmcnt(0)
v_mfma_f32_32x32x16_f16 v[96:111], v[92:95], v[60:63], v[96:111]
s_waitcnt vmcnt(0)
v_mov_b32 v11, 0x3f803f80
v_mov_b32 v12, 0
v_mov_b32 v13, 0
v_mov_b32 v14, 0
v_mov_b32 v15, 0
v_lshlrev_b32 v16, 16, v120
v_and_b32 v17, 0xffff0000, v120
s_nop 3
v_add_f32 v16, v16, v96
v_add_f32 v17, v17, v97
v_cvt_pk_bf16_f32 v120, v16, v17
v_dot2c_f32_bf16 v14, v120, v11
v_dot2c_f32_bf16 v15, v120, v120
v_lshlrev_b32 v16, 16, v121
v_and_b32 v17, 0xffff0000, v121
v_add_f32 v16, v16, v98
v_add_f32 v17, v17, v99
v_cvt_pk_bf16_f32 v121, v16, v17
v_dot2c_f32_bf16 v14, v121, v11
v_dot2c_f32_bf16 v15, v121, v121
v_lshlrev_b32 v16, 16, v122
v_and_b32 v17, 0xffff0000, v122
v_add_f32 v16, v16, v100
v_add_f32 v17, v17, v101
v_cvt_pk_bf16_f32 v122, v16, v17
v_dot2c_f32_bf16 v14, v122, v11
v_dot2c_f32_bf16 v15, v122, v122
v_lshlrev_b32 v16, 16, v123
v_and_b32 v17, 0xffff0000, v123
v_add_f32 v16, v16, v102
v_add_f32 v17, v17, v103
v_cvt_pk_bf16_f32 v123, v16, v17
v_dot2c_f32_bf16 v14, v123, v11
v_dot2c_f32_bf16 v15, v123, v123
v_lshlrev_b32 v16, 16, v124
v_and_b32 v17, 0xffff0000, v124
v_add_f32 v16, v16, v104
v_add_f32 v17, v17, v105
v_cvt_pk_bf16_f32 v124, v16, v17
v_dot2c_f32_bf16 v14, v124, v11
v_dot2c_f32_bf16 v15, v124, v124
v_lshlrev_b32 v16, 16, v125
v_and_b32 v17, 0xffff0000, v125
v_add_f32 v16, v16, v106
v_add_f32 v17, v17, v107
v_cvt_pk_bf16_f32 v125, v16, v17
v_dot2c_f32_bf16 v14, v125, v11
v_dot2c_f32_bf16 v15, v125, v125
v_lshlrev_b32 v16, 16, v126
v_and_b32 v17, 0xffff0000, v126
v_add_f32 v16, v16, v108
v_add_f32 v17, v17, v109
v_cvt_pk_bf16_f32 v126, v16, v17
v_dot2c_f32_bf16 v14, v126, v11
v_dot2c_f32_bf16 v15, v126, v126
v_lshlrev_b32 v16, 16, v127
v_and_b32 v17, 0xffff0000, v127
v_add_f32 v16, v16, v110
v_add_f32 v17, v17, v111
v_cvt_pk_bf16_f32 v127, v16, v17
v_dot2c_f32_bf16 v14, v127, v11
v_dot2c_f32_bf16 v15, v127, v127
s_add_u32 s4, s33, 3145728
buffer_store_dwordx4 v[120:123], v6, s[8:11], s4 offen offset:0 sc1
buffer_store_dwordx4 v[124:127], v6, s[8:11], s4 offen offset:1024 sc1
s_cmp_lg_u32 s25, 0
s_cbranch_scc1 l2_kernel_nodc
v_cmp_eq_u32 vcc, 0, v3
s_nop 1
v_cndmask_b32 v96, v96, 0, vcc
l2_kernel_nodc:
v_lshlrev_b32 v16, 16, v112
v_and_b32 v17, 0xffff0000, v112
v_add_f32 v16, v16, v96
v_add_f32 v17, v17, v97
v_cvt_pk_bf16_f32 v112, v16, v17
v_dot2c_f32_bf16 v12, v112, v11
v_dot2c_f32_bf16 v13, v112, v112
v_lshlrev_b32 v16, 16, v113
v_and_b32 v17, 0xffff0000, v113
v_add_f32 v16, v16, v98
v_add_f32 v17, v17, v99
v_cvt_pk_bf16_f32 v113, v16, v17
v_dot2c_f32_bf16 v12, v113, v11
v_dot2c_f32_bf16 v13, v113, v113
v_lshlrev_b32 v16, 16, v114
v_and_b32 v17, 0xffff0000, v114
v_add_f32 v16, v16, v100
v_add_f32 v17, v17, v101
v_cvt_pk_bf16_f32 v114, v16, v17
v_dot2c_f32_bf16 v12, v114, v11
v_dot2c_f32_bf16 v13, v114, v114
v_lshlrev_b32 v16, 16, v115
v_and_b32 v17, 0xffff0000, v115
v_add_f32 v16, v16, v102
v_add_f32 v17, v17, v103
v_cvt_pk_bf16_f32 v115, v16, v17
v_dot2c_f32_bf16 v12, v115, v11
v_dot2c_f32_bf16 v13, v115, v115
v_lshlrev_b32 v16, 16, v116
v_and_b32 v17, 0xffff0000, v116
v_add_f32 v16, v16, v104
v_add_f32 v17, v17, v105
v_cvt_pk_bf16_f32 v116, v16, v17
v_dot2c_f32_bf16 v12, v116, v11
v_dot2c_f32_bf16 v13, v116, v116
v_lshlrev_b32 v16, 16, v117
v_and_b32 v17, 0xffff0000, v117
v_add_f32 v16, v16, v106
v_add_f32 v17, v17, v107
v_cvt_pk_bf16_f32 v117, v16, v17
v_dot2c_f32_bf16 v12, v117, v11
v_dot2c_f32_bf16 v13, v117, v117
v_lshlrev_b32 v16, 16, v118
v_and_b32 v17, 0xffff0000, v118
v_add_f32 v16, v16, v108
v_add_f32 v17, v17, v109
v_cvt_pk_bf16_f32 v118, v16, v17
v_dot2c_f32_bf16 v12, v118, v11
v_dot2c_f32_bf16 v13, v118, v118
v_lshlrev_b32 v16, 16, v119
v_and_b32 v17, 0xffff0000, v119
v_add_f32 v16, v16, v110
v_add_f32 v17, v17, v111
v_cvt_pk_bf16_f32 v119, v16, v17
v_dot2c_f32_bf16 v12, v119, v11
v_dot2c_f32_bf16 v13, v119, v119
s_add_u32 s5, s32, 3145728
buffer_store_dwordx4 v[112:115], v1, s[8:11], s5 offen offset:0 sc1
buffer_store_dwordx4 v[116:119], v1, s[8:11], s5 offen offset:1024 sc1
v_mov_b32 v16, v12
s_nop 1
v_permlane32_swap_b32 v16, v12
v_add_f32 v12, v12, v16
v_mov_b32 v16, v13
s_nop 1
v_permlane32_swap_b32 v16, v13
v_add_f32 v13, v13, v16
v_mov_b32 v16, v14
s_nop 1
v_permlane32_swap_b32 v16, v14
v_add_f32 v14, v14, v16
v_mov_b32 v16, v15
s_nop 1
v_permlane32_swap_b32 v16, v15
v_add_f32 v15, v15, v16
s_mul_i32 s3, s27, 5120
s_lshl_b32 s6, s25, 8
s_add_u32 s3, s3, s6
s_mul_i32 s4, s28, 5120
s_add_u32 s4, s4, s6
s_add_u32 s4, s4, 2560
v_lshl_add_u32 v16, v2, 3, s3
v_lshl_add_u32 v17, v5, 3, s4
v_cmp_eq_u32 vcc, 0, v3
s_nop 1
v_cndmask_b32 v16, v17, v16, vcc
v_cndmask_b32 v12, v14, v12, vcc
v_cndmask_b32 v13, v15, v13, vcc
s_mov_b32 s3, 42205184
s_add_u32 s3, s3, s75
buffer_store_dwordx2 v[12:13], v16, s[8:11], s3 offen sc1
s_cmp_eq_u32 s76, 1
s_cbranch_scc1 l2_kernel_wdoneA
s_add_u32 s4, s34, s35
s_add_u32 s4, s4, 0
s_add_u32 m0, s34, 0
s_nop 0
buffer_load_dwordx4 v1, s[8:11], s4 offen  lds
buffer_load_dwordx4 v1, s[8:11], s4 offen offset:1024  lds
buffer_load_dwordx4 v1, s[8:11], s4 offen offset:2048  lds
buffer_load_dwordx4 v1, s[8:11], s4 offen offset:3072  lds
s_add_u32 s4, s4, 4096
s_add_u32 m0, m0, 4096
s_nop 0
buffer_load_dwordx4 v1, s[8:11], s4 offen  lds
s_add_u32 s4, s34, s35
s_add_u32 s4, s4, 40960
s_add_u32 m0, s34, 40960
s_nop 0
buffer_load_dwordx4 v1, s[8:11], s4 offen  lds
buffer_load_dwordx4 v1, s[8:11], s4 offen offset:1024  lds
buffer_load_dwordx4 v1, s[8:11], s4 offen offset:2048  lds
buffer_load_dwordx4 v1, s[8:11], s4 offen offset:3072  lds
s_add_u32 s4, s4, 4096
s_add_u32 m0, m0, 4096
s_nop 0
buffer_load_dwordx4 v1, s[8:11], s4 offen  lds
s_add_u32 s4, s34, s35
s_add_u32 s4, s4, 20480
s_add_u32 m0, s34, 20480
s_nop 0
buffer_load_dwordx4 v1, s[8:11], s4 offen  lds
buffer_load_dwordx4 v1, s[8:11], s4 offen offset:1024  lds
buffer_load_dwordx4 v1, s[8:11], s4 offen offset:2048  lds
buffer_load_dwordx4 v1, s[8:11], s4 offen offset:3072  lds
s_add_u32 s4, s4, 4096
s_add_u32 m0, m0, 4096
s_nop 0
buffer_load_dwordx4 v1, s[8:11], s4 offen  lds
s_add_u32 s4, s34, s35
s_add_u32 s4, s4, 61440
s_add_u32 m0, s34, 61440
s_nop 0
buffer_load_dwordx4 v1, s[8:11], s4 offen  lds
buffer_load_dwordx4 v1, s[8:11], s4 offen offset:1024  lds
buffer_load_dwordx4 v1, s[8:11], s4 offen offset:2048  lds
buffer_load_dwordx4 v1, s[8:11], s4 offen offset:3072  lds
s_add_u32 s4, s4, 4096
s_add_u32 m0, m0, 4096
s_nop 0
buffer_load_dwordx4 v1, s[8:11], s4 offen  lds
s_add_u32 s4, s34, s35
s_add_u32 s4, s4, 81920
s_add_u32 m0, s34, 81920
s_nop 0
buffer_load_dwordx4 v1, s[8:11], s4 offen  lds
buffer_load_dwordx4 v1, s[8:11], s4 offen offset:1024  lds
buffer_load_dwordx4 v1, s[8:11], s4 offen offset:2048  lds
buffer_load_dwordx4 v1, s[8:11], s4 offen offset:3072  lds
s_add_u32 s4, s4, 4096
s_add_u32 m0, m0, 4096
s_nop 0
buffer_load_dwordx4 v1, s[8:11], s4 offen  lds
s_add_u32 s4, s34, s35
s_add_u32 s4, s4, 102400
s_add_u32 m0, s34, 102400
s_nop 0
buffer_load_dwordx4 v1, s[8:11], s4 offen  lds
buffer_load_dwordx4 v1, s[8:11], s4 offen offset:1024  lds
buffer_load_dwordx4 v1, s[8:11], s4 offen offset:2048  lds
buffer_load_dwordx4 v1, s[8:11], s4 offen offset:3072  lds
s_add_u32 s4, s4, 4096
s_add_u32 m0, m0, 4096
s_nop 0
buffer_load_dwordx4 v1, s[8:11], s4 offen  lds
s_waitcnt vmcnt(30)
s_branch l2_kernel_wdoneA2
l2_kernel_wdoneA:
s_waitcnt vmcnt(0)
l2_kernel_wdoneA2:
s_barrier
s_cmp_lg_u32 s20, 0
s_cbranch_scc1 l2_kernel_sig0
s_lshl_b32 s3, s22, 2
v_mov_b32 v10, s3
v_mov_b32 v11, 1
s_mov_b64 exec, 1
v_mov_b32 v10, 0
buffer_atomic_add v11, v10, s[8:11], s80 offen sc1
s_mov_b64 exec, -1
l2_kernel_sig0:
s_branch l2_kernel_f2j
l2_kernel_nof2b:
s_cmp_eq_u32 s76, 1
s_cbranch_scc1 l2_kernel_f2j
s_add_u32 s4, s34, s35
s_add_u32 s4, s4, 0
s_add_u32 m0, s34, 0
s_nop 0
buffer_load_dwordx4 v1, s[8:11], s4 offen  lds
buffer_load_dwordx4 v1, s[8:11], s4 offen offset:1024  lds
buffer_load_dwordx4 v1, s[8:11], s4 offen offset:2048  lds
buffer_load_dwordx4 v1, s[8:11], s4 offen offset:3072  lds
s_add_u32 s4, s4, 4096
s_add_u32 m0, m0, 4096
s_nop 0
buffer_load_dwordx4 v1, s[8:11], s4 offen  lds
s_add_u32 s4, s34, s35
s_add_u32 s4, s4, 40960
s_add_u32 m0, s34, 40960
s_nop 0
buffer_load_dwordx4 v1, s[8:11], s4 offen  lds
buffer_load_dwordx4 v1, s[8:11], s4 offen offset:1024  lds
buffer_load_dwordx4 v1, s[8:11], s4 offen offset:2048  lds
buffer_load_dwordx4 v1, s[8:11], s4 offen offset:3072  lds
s_add_u32 s4, s4, 4096
s_add_u32 m0, m0, 4096
s_nop 0
buffer_load_dwordx4 v1, s[8:11], s4 offen  lds
s_add_u32 s4, s34, s35
s_add_u32 s4, s4, 20480
s_add_u32 m0, s34, 20480
s_nop 0
buffer_load_dwordx4 v1, s[8:11], s4 offen  lds
buffer_load_dwordx4 v1, s[8:11], s4 offen offset:1024  lds
buffer_load_dwordx4 v1, s[8:11], s4 offen offset:2048  lds
buffer_load_dwordx4 v1, s[8:11], s4 offen offset:3072  lds
s_add_u32 s4, s4, 4096
s_add_u32 m0, m0, 4096
s_nop 0
buffer_load_dwordx4 v1, s[8:11], s4 offen  lds
s_add_u32 s4, s34, s35
s_add_u32 s4, s4, 61440
s_add_u32 m0, s34, 61440
s_nop 0
buffer_load_dwordx4 v1, s[8:11], s4 offen  lds
buffer_load_dwordx4 v1, s[8:11], s4 offen offset:1024  lds
buffer_load_dwordx4 v1, s[8:11], s4 offen offset:2048  lds
buffer_load_dwordx4 v1, s[8:11], s4 offen offset:3072  lds
s_add_u32 s4, s4, 4096
s_add_u32 m0, m0, 4096
s_nop 0
buffer_load_dwordx4 v1, s[8:11], s4 offen  lds
s_add_u32 s4, s34, s35
s_add_u32 s4, s4, 81920
s_add_u32 m0, s34, 81920
s_nop 0
buffer_load_dwordx4 v1, s[8:11], s4 offen  lds
buffer_load_dwordx4 v1, s[8:11], s4 offen offset:1024  lds
buffer_load_dwordx4 v1, s[8:11], s4 offen offset:2048  lds
buffer_load_dwordx4 v1, s[8:11], s4 offen offset:3072  lds
s_add_u32 s4, s4, 4096
s_add_u32 m0, m0, 4096
s_nop 0
buffer_load_dwordx4 v1, s[8:11], s4 offen  lds
s_add_u32 s4, s34, s35
s_add_u32 s4, s4, 102400
s_add_u32 m0, s34, 102400
s_nop 0
buffer_load_dwordx4 v1, s[8:11], s4 offen  lds
buffer_load_dwordx4 v1, s[8:11], s4 offen offset:1024  lds
buffer_load_dwordx4 v1, s[8:11], s4 offen offset:2048  lds
buffer_load_dwordx4 v1, s[8:11], s4 offen offset:3072  lds
s_add_u32 s4, s4, 4096
s_add_u32 m0, m0, 4096
s_nop 0
buffer_load_dwordx4 v1, s[8:11], s4 offen  lds
l2_kernel_f2j:
s_cmp_eq_u32 s67, 1
s_cbranch_scc1 l2_kernel_nocs
s_lshl_b32 s4, s79, 7
s_add_u32 s4, s4, 41943040
v_lshlrev_b32 v122, 2, v0
buffer_load_dword v112, v122, s[8:11], s4 offen
s_add_u32 s4, s4, 13824
buffer_load_dword v113, v122, s[8:11], s4 offen
s_add_u32 s4, s4, 13824
buffer_load_dword v114, v122, s[8:11], s4 offen
s_add_u32 s4, s4, 13824
buffer_load_dword v115, v122, s[8:11], s4 offen
s_add_u32 s4, s4, 13824
buffer_load_dword v116, v122, s[8:11], s4 offen
s_add_u32 s4, s4, 13824
buffer_load_dword v117, v122, s[8:11], s4 offen
s_add_u32 s4, s4, 13824
buffer_load_dword v118, v122, s[8:11], s4 offen
s_add_u32 s4, s4, 13824
buffer_load_dword v119, v122, s[8:11], s4 offen
s_add_u32 s4, s4, 13824
buffer_load_dword v120, v122, s[8:11], s4 offen
s_add_u32 s4, s4, 13824
buffer_load_dword v121, v122, s[8:11], s4 offen
l2_kernel_nocs:
s_mul_i32 s5, s40, 5120
v_add_u32 v30, s5, v1
buffer_load_dwordx4 a[160:163], v30, s[8:11], s54 offen offset:0
buffer_load_dwordx4 a[164:167], v30, s[8:11], s54 offen offset:1024
buffer_load_dwordx4 a[168:171], v30, s[8:11], s54 offen offset:2048
buffer_load_dwordx4 a[172:175], v30, s[8:11], s54 offen offset:3072
buffer_load_dwordx4 a[176:179], v30, s[8:11], s55 offen
s_mul_i32 s5, s41, 5120
v_add_u32 v30, s5, v1
buffer_load_dwordx4 a[180:183], v30, s[8:11], s54 offen offset:0
buffer_load_dwordx4 a[184:187], v30, s[8:11], s54 offen offset:1024
buffer_load_dwordx4 a[188:191], v30, s[8:11], s54 offen offset:2048
buffer_load_dwordx4 a[192:195], v30, s[8:11], s54 offen offset:3072
buffer_load_dwordx4 a[196:199], v30, s[8:11], s55 offen
s_mul_i32 s5, s42, 5120
v_add_u32 v30, s5, v1
buffer_load_dwordx4 a[200:203], v30, s[8:11], s54 offen offset:0
buffer_load_dwordx4 a[204:207], v30, s[8:11], s54 offen offset:1024
buffer_load_dwordx4 a[208:211], v30, s[8:11], s54 offen offset:2048
buffer_load_dwordx4 a[212:215], v30, s[8:11], s54 offen offset:3072
buffer_load_dwordx4 a[216:219], v30, s[8:11], s55 offen
s_mul_i32 s5, s43, 5120
v_add_u32 v30, s5, v1
buffer_load_dwordx4 a[220:223], v30, s[8:11], s54 offen offset:0
buffer_load_dwordx4 a[224:227], v30, s[8:11], s54 offen offset:1024
buffer_load_dwordx4 a[228:231], v30, s[8:11], s54 offen offset:2048
buffer_load_dwordx4 a[232:235], v30, s[8:11], s54 offen offset:3072
buffer_load_dwordx4 a[236:239], v30, s[8:11], s55 offen
s_mul_i32 s5, s44, 5120
v_add_u32 v30, s5, v1
buffer_load_dwordx4 a[240:243], v30, s[8:11], s54 offen offset:0
buffer_load_dwordx4 a[244:247], v30, s[8:11], s54 offen offset:1024
buffer_load_dwordx4 a[248:251], v30, s[8:11], s54 offen offset:2048
buffer_load_dwordx4 a[252:255], v30, s[8:11], s54 offen offset:3072
buffer_load_dwordx4 v[128:131], v30, s[8:11], s55 offen
s_mul_i32 s5, s45, 5120
v_add_u32 v30, s5, v1
buffer_load_dwordx4 v[132:135], v30, s[8:11], s54 offen offset:0
buffer_load_dwordx4 v[136:139], v30, s[8:11], s54 offen offset:1024
buffer_load_dwordx4 v[140:143], v30, s[8:11], s54 offen offset:2048
s_waitcnt vmcnt(28)
s_branch l2_kernel_nowd1
l2_kernel_nowd0:
s_waitcnt vmcnt(0)
l2_kernel_nowd1:
v_and_b32 v10, 63, v0
v_lshlrev_b32 v1, 4, v10
v_and_b32 v2, 31, v0
v_bfe_u32 v3, v0, 5, 1
v_lshrrev_b32 v10, 4, v2
v_mul_u32_u24 v10, 55296, v10
v_lshl_add_u32 v10, v3, 8, v10
v_and_b32 v11, 15, v0
v_lshl_add_u32 v8, v11, 4, v10
v_lshlrev_b32 v9, 6, v3
v_add_u32 v9, 139776, v9
s_cmp_lg_u32 s20, 3
s_cbranch_scc1 l2_kernel_nopoll0
s_mov_b32 s7, 0
l2_kernel_p0_retry:
v_mov_b32 v10, 0
buffer_load_dword v11, v10, s[8:11], s80 offen sc1
s_waitcnt vmcnt(0)
v_cmp_gt_u32 vcc, 10, v11
s_nop 4
s_cbranch_vccz l2_kernel_p0_ok
s_add_u32 s7, s7, 1
s_cmp_lt_u32 s7, 400000
s_cbranch_scc0 l2_kernel_p0_ok
s_branch l2_kernel_p0_retry
l2_kernel_p0_ok:
l2_kernel_nopoll0:
s_barrier
v_mul_u32_u24 v30, 2560, v3
v_lshl_add_u32 v30, v2, 3, v30
buffer_load_dwordx2 v[10:11], v30, s[8:11], s39 offen offset:0 sc1
buffer_load_dwordx2 v[12:13], v30, s[8:11], s39 offen offset:256 sc1
buffer_load_dwordx2 v[14:15], v30, s[8:11], s39 offen offset:512 sc1
buffer_load_dwordx2 v[16:17], v30, s[8:11], s39 offen offset:768 sc1
buffer_load_dwordx2 v[18:19], v30, s[8:11], s39 offen offset:1024 sc1
buffer_load_dwordx2 v[20:21], v30, s[8:11], s39 offen offset:1280 sc1
buffer_load_dwordx2 v[22:23], v30, s[8:11], s39 offen offset:1536 sc1
buffer_load_dwordx2 v[24:25], v30, s[8:11], s39 offen offset:1792 sc1
buffer_load_dwordx2 v[26:27], v30, s[8:11], s39 offen offset:2048 sc1
buffer_load_dwordx2 v[28:29], v30, s[8:11], s39 offen offset:2304 sc1
buffer_load_dwordx4 a[0:3], v1, s[8:11], s38 offen offset:0 sc1
buffer_load_dwordx4 a[4:7], v1, s[8:11], s38 offen offset:1024 sc1
buffer_load_dwordx4 a[8:11], v1, s[8:11], s38 offen offset:2048 sc1
buffer_load_dwordx4 a[12:15], v1, s[8:11], s38 offen offset:3072 sc1
s_add_u32 s38, s38, 4096
buffer_load_dwordx4 a[16:19], v1, s[8:11], s38 offen offset:0 sc1
buffer_load_dwordx4 a[20:23], v1, s[8:11], s38 offen offset:1024 sc1
buffer_load_dwordx4 a[24:27], v1, s[8:11], s38 offen offset:2048 sc1
buffer_load_dwordx4 a[28:31], v1, s[8:11], s38 offen offset:3072 sc1
s_add_u32 s38, s38, 4096
buffer_load_dwordx4 a[32:35], v1, s[8:11], s38 offen offset:0 sc1
buffer_load_dwordx4 a[36:39], v1, s[8:11], s38 offen offset:1024 sc1
s_waitcnt vmcnt(10)
v_add_f32 v10, v10, v12
v_add_f32 v11, v11, v13
v_add_f32 v10, v10, v14
v_add_f32 v11, v11, v15
v_add_f32 v10, v10, v16
v_add_f32 v11, v11, v17
v_add_f32 v10, v10, v18
v_add_f32 v11, v11, v19
v_add_f32 v10, v10, v20
v_add_f32 v11, v11, v21
v_add_f32 v10, v10, v22
v_add_f32 v11, v11, v23
v_add_f32 v10, v10, v24
v_add_f32 v11, v11, v25
v_add_f32 v10, v10, v26
v_add_f32 v11, v11, v27
v_add_f32 v10, v10, v28
v_add_f32 v11, v11, v29
v_mov_b32 v12, v10
s_nop 1
v_permlane32_swap_b32 v12, v10
v_add_f32 v10, v10, v12
v_mov_b32 v12, v11
s_nop 1
v_permlane32_swap_b32 v12, v11
v_add_f32 v11, v11, v12
v_mul_f32 v10, 0x3acccccd, v10
v_mul_f32 v11, 0x3acccccd, v11
v_fma_f32 v11, -v10, v10, v11
v_max_f32 v11, 0, v11
v_add_f32 v11, 0x3727c5ac, v11
v_rsq_f32 v4, v11
s_nop 0
v_mul_f32 v5, v4, v10
v_mul_f32 v6, 0xbfb8aa3b, v4
v_mul_f32 v7, 0x3fb8aa3b, v5
v_sub_f32 v5, 0, v5
v_add_u32 v30, 61440, v1
ds_read_b128 v[32:35], v1 offset:0
ds_read_b128 v[36:39], v1 offset:40960
ds_read_b128 v[40:43], v1 offset:1024
ds_read_b128 v[44:47], v1 offset:41984
ds_read_b128 v[48:51], v1 offset:2048
buffer_load_dwordx4 a[40:43], v1, s[8:11], s38 offen offset:2048 sc1
s_waitcnt vmcnt(10)
s_waitcnt lgkmcnt(4)
v_mfma_f32_32x32x16_bf16 v[64:79], v[32:35], a[0:3], 0
ds_read_b128 v[52:55], v1 offset:43008
s_waitcnt lgkmcnt(4)
v_mfma_f32_32x32x16_bf16 v[80:95], v[36:39], a[0:3], 0
ds_read_b128 v[56:59], v1 offset:3072
buffer_load_dwordx4 a[44:47], v1, s[8:11], s38 offen offset:3072 sc1
s_waitcnt vmcnt(10)
s_waitcnt lgkmcnt(4)
v_mfma_f32_32x32x16_bf16 v[64:79], v[40:43], a[4:7], v[64:79]
ds_read_b128 v[60:63], v1 offset:44032
s_waitcnt lgkmcnt(4)
v_mfma_f32_32x32x16_bf16 v[80:95], v[44:47], a[4:7], v[80:95]
ds_read_b128 v[32:35], v1 offset:4096
s_add_u32 s38, s38, 4096
buffer_load_dwordx4 a[48:51], v1, s[8:11], s38 offen offset:0 sc1
s_waitcnt vmcnt(10)
s_waitcnt lgkmcnt(4)
v_mfma_f32_32x32x16_bf16 v[64:79], v[48:51], a[8:11], v[64:79]
ds_read_b128 v[36:39], v1 offset:45056
s_waitcnt lgkmcnt(4)
v_mfma_f32_32x32x16_bf16 v[80:95], v[52:55], a[8:11], v[80:95]
ds_read_b128 v[40:43], v1 offset:5120
buffer_load_dwordx4 a[52:55], v1, s[8:11], s38 offen offset:1024 sc1
s_waitcnt vmcnt(10)
s_waitcnt lgkmcnt(4)
v_mfma_f32_32x32x16_bf16 v[64:79], v[56:59], a[12:15], v[64:79]
ds_read_b128 v[44:47], v1 offset:46080
s_waitcnt lgkmcnt(4)
v_mfma_f32_32x32x16_bf16 v[80:95], v[60:63], a[12:15], v[80:95]
ds_read_b128 v[48:51], v1 offset:6144
buffer_load_dwordx4 a[56:59], v1, s[8:11], s38 offen offset:2048 sc1
s_waitcnt vmcnt(10)
s_waitcnt lgkmcnt(4)
v_mfma_f32_32x32x16_bf16 v[64:79], v[32:35], a[16:19], v[64:79]
ds_read_b128 v[52:55], v1 offset:47104
s_waitcnt lgkmcnt(4)
v_mfma_f32_32x32x16_bf16 v[80:95], v[36:39], a[16:19], v[80:95]
ds_read_b128 v[56:59], v1 offset:7168
buffer_load_dwordx4 a[60:63], v1, s[8:11], s38 offen offset:3072 sc1
s_waitcnt vmcnt(10)
s_waitcnt lgkmcnt(4)
v_mfma_f32_32x32x16_bf16 v[64:79], v[40:43], a[20:23], v[64:79]
ds_read_b128 v[60:63], v1 offset:48128
s_waitcnt lgkmcnt(4)
v_mfma_f32_32x32x16_bf16 v[80:95], v[44:47], a[20:23], v[80:95]
ds_read_b128 v[32:35], v1 offset:8192
s_add_u32 s38, s38, 4096
buffer_load_dwordx4 a[64:67], v1, s[8:11], s38 offen offset:0 sc1
s_waitcnt vmcnt(10)
s_waitcnt lgkmcnt(4)
v_mfma_f32_32x32x16_bf16 v[64:79], v[48:51], a[24:27], v[64:79]
ds_read_b128 v[36:39], v1 offset:49152
s_waitcnt lgkmcnt(4)
v_mfma_f32_32x32x16_bf16 v[80:95], v[52:55], a[24:27], v[80:95]
ds_read_b128 v[40:43], v1 offset:9216
buffer_load_dwordx4 a[68:71], v1, s[8:11], s38 offen offset:1024 sc1
s_waitcnt vmcnt(10)
s_waitcnt lgkmcnt(4)
v_mfma_f32_32x32x16_bf16 v[64:79], v[56:59], a[28:31], v[64:79]
ds_read_b128 v[44:47], v1 offset:50176
s_waitcnt lgkmcnt(4)
v_mfma_f32_32x32x16_bf16 v[80:95], v[60:63], a[28:31], v[80:95]
ds_read_b128 v[48:51], v1 offset:10240
buffer_load_dwordx4 a[72:75], v1, s[8:11], s38 offen offset:2048 sc1
s_waitcnt vmcnt(10)
s_waitcnt lgkmcnt(4)
v_mfma_f32_32x32x16_bf16 v[64:79], v[32:35], a[32:35], v[64:79]
ds_read_b128 v[52:55], v1 offset:51200
s_waitcnt lgkmcnt(4)
v_mfma_f32_32x32x16_bf16 v[80:95], v[36:39], a[32:35], v[80:95]
ds_read_b128 v[56:59], v1 offset:11264
buffer_load_dwordx4 a[76:79], v1, s[8:11], s38 offen offset:3072 sc1
s_waitcnt vmcnt(10)
s_waitcnt lgkmcnt(4)
v_mfma_f32_32x32x16_bf16 v[64:79], v[40:43], a[36:39], v[64:79]
ds_read_b128 v[60:63], v1 offset:52224
s_waitcnt lgkmcnt(4)
v_mfma_f32_32x32x16_bf16 v[80:95], v[44:47], a[36:39], v[80:95]
ds_read_b128 v[32:35], v1 offset:12288
s_add_u32 s38, s38, 4096
buffer_load_dwordx4 a[80:83], v1, s[8:11], s38 offen offset:0 sc1
s_waitcnt vmcnt(10)
s_waitcnt lgkmcnt(4)
v_mfma_f32_32x32x16_bf16 v[64:79], v[48:51], a[40:43], v[64:79]
ds_read_b128 v[36:39], v1 offset:53248
s_waitcnt lgkmcnt(4)
v_mfma_f32_32x32x16_bf16 v[80:95], v[52:55], a[40:43], v[80:95]
ds_read_b128 v[40:43], v1 offset:13312
buffer_load_dwordx4 a[84:87], v1, s[8:11], s38 offen offset:1024 sc1
s_waitcnt vmcnt(10)
s_waitcnt lgkmcnt(4)
v_mfma_f32_32x32x16_bf16 v[64:79], v[56:59], a[44:47], v[64:79]
ds_read_b128 v[44:47], v1 offset:54272
s_waitcnt lgkmcnt(4)
v_mfma_f32_32x32x16_bf16 v[80:95], v[60:63], a[44:47], v[80:95]
ds_read_b128 v[48:51], v1 offset:14336
buffer_load_dwordx4 a[88:91], v1, s[8:11], s38 offen offset:2048 sc1
s_waitcnt vmcnt(10)
s_waitcnt lgkmcnt(4)
v_mfma_f32_32x32x16_bf16 v[64:79], v[32:35], a[48:51], v[64:79]
ds_read_b128 v[52:55], v1 offset:55296
s_waitcnt lgkmcnt(4)
v_mfma_f32_32x32x16_bf16 v[80:95], v[36:39], a[48:51], v[80:95]
ds_read_b128 v[56:59], v1 offset:15360
buffer_load_dwordx4 a[92:95], v1, s[8:11], s38 offen offset:3072 sc1
s_waitcnt vmcnt(10)
s_waitcnt lgkmcnt(4)
v_mfma_f32_32x32x16_bf16 v[64:79], v[40:43], a[52:55], v[64:79]
ds_read_b128 v[60:63], v1 offset:56320
s_waitcnt lgkmcnt(4)
v_mfma_f32_32x32x16_bf16 v[80:95], v[44:47], a[52:55], v[80:95]
ds_read_b128 v[32:35], v1 offset:16384
s_add_u32 s38, s38, 4096
buffer_load_dwordx4 a[96:99], v1, s[8:11], s38 offen offset:0 sc1
s_waitcnt vmcnt(10)
s_waitcnt lgkmcnt(4)
v_mfma_f32_32x32x16_bf16 v[64:79], v[48:51], a[56:59], v[64:79]
ds_read_b128 v[36:39], v1 offset:57344
s_waitcnt lgkmcnt(4)
v_mfma_f32_32x32x16_bf16 v[80:95], v[52:55], a[56:59], v[80:95]
ds_read_b128 v[40:43], v1 offset:17408
buffer_load_dwordx4 a[100:103], v1, s[8:11], s38 offen offset:1024 sc1
s_waitcnt vmcnt(10)
s_waitcnt lgkmcnt(4)
v_mfma_f32_32x32x16_bf16 v[64:79], v[56:59], a[60:63], v[64:79]
ds_read_b128 v[44:47], v1 offset:58368
s_waitcnt lgkmcnt(4)
v_mfma_f32_32x32x16_bf16 v[80:95], v[60:63], a[60:63], v[80:95]
ds_read_b128 v[48:51], v1 offset:18432
buffer_load_dwordx4 a[104:107], v1, s[8:11], s38 offen offset:2048 sc1
s_waitcnt vmcnt(10)
s_waitcnt lgkmcnt(4)
v_mfma_f32_32x32x16_bf16 v[64:79], v[32:35], a[64:67], v[64:79]
ds_read_b128 v[52:55], v1 offset:59392
s_waitcnt lgkmcnt(4)
v_mfma_f32_32x32x16_bf16 v[80:95], v[36:39], a[64:67], v[80:95]
ds_read_b128 v[56:59], v1 offset:19456
buffer_load_dwordx4 a[108:111], v1, s[8:11], s38 offen offset:3072 sc1
s_waitcnt vmcnt(10)
s_waitcnt lgkmcnt(4)
v_mfma_f32_32x32x16_bf16 v[64:79], v[40:43], a[68:71], v[64:79]
ds_read_b128 v[60:63], v1 offset:60416
s_waitcnt lgkmcnt(4)
v_mfma_f32_32x32x16_bf16 v[80:95], v[44:47], a[68:71], v[80:95]
ds_read_b128 v[32:35], v1 offset:20480
s_add_u32 s38, s38, 4096
buffer_load_dwordx4 a[112:115], v1, s[8:11], s38 offen offset:0 sc1
s_waitcnt vmcnt(10)
s_waitcnt lgkmcnt(4)
v_mfma_f32_32x32x16_bf16 v[64:79], v[48:51], a[72:75], v[64:79]
ds_read_b128 v[36:39], v1 offset:61440
s_waitcnt lgkmcnt(4)
v_mfma_f32_32x32x16_bf16 v[80:95], v[52:55], a[72:75], v[80:95]
ds_read_b128 v[40:43], v1 offset:21504
buffer_load_dwordx4 a[116:119], v1, s[8:11], s38 offen offset:1024 sc1
s_waitcnt vmcnt(10)
s_waitcnt lgkmcnt(4)
v_mfma_f32_32x32x16_bf16 v[64:79], v[56:59], a[76:79], v[64:79]
ds_read_b128 v[44:47], v1 offset:62464
s_waitcnt lgkmcnt(4)
v_mfma_f32_32x32x16_bf16 v[80:95], v[60:63], a[76:79], v[80:95]
ds_read_b128 v[48:51], v1 offset:22528
s_barrier
buffer_load_dwordx4 a[120:123], v1, s[8:11], s38 offen offset:2048 sc1
s_waitcnt vmcnt(10)
s_waitcnt lgkmcnt(4)
v_mfma_f32_32x32x16_bf16 v[64:79], v[32:35], a[80:83], v[64:79]
ds_read_b128 v[52:55], v1 offset:63488
s_waitcnt lgkmcnt(4)
v_mfma_f32_32x32x16_bf16 v[80:95], v[36:39], a[80:83], v[80:95]
ds_read_b128 v[56:59], v1 offset:23552
buffer_load_dwordx4 a[124:127], v1, s[8:11], s38 offen offset:3072 sc1
s_waitcnt vmcnt(10)
s_waitcnt lgkmcnt(4)
v_mfma_f32_32x32x16_bf16 v[64:79], v[40:43], a[84:87], v[64:79]
ds_read_b128 v[60:63], v1 offset:64512
s_add_u32 s4, s34, s35
s_add_u32 s4, s4, 122880
s_add_u32 m0, s34, 0
s_nop 0
buffer_load_dwordx4 v1, s[8:11], s4 offen  lds
s_waitcnt lgkmcnt(4)
v_mfma_f32_32x32x16_bf16 v[80:95], v[44:47], a[84:87], v[80:95]
ds_read_b128 v[32:35], v1 offset:24576
s_add_u32 s38, s38, 4096
buffer_load_dwordx4 a[128:131], v1, s[8:11], s38 offen offset:0 sc1
s_waitcnt vmcnt(11)
s_waitcnt lgkmcnt(4)
v_mfma_f32_32x32x16_bf16 v[64:79], v[48:51], a[88:91], v[64:79]
ds_read_b128 v[36:39], v30 offset:4096
s_mul_i32 s5, s45, 5120
v_add_u32 v31, s5, v1
buffer_load_dwordx4 v[144:147], v31, s[8:11], s54 offen offset:3072
s_cmp_eq_u32 s67, 1
s_cbranch_scc1 l2_kernel_nocs2
v_add_f32 v112, v112, v113
v_add_f32 v112, v112, v114
v_add_f32 v112, v112, v115
v_add_f32 v112, v112, v116
v_add_f32 v112, v112, v117
v_add_f32 v112, v112, v118
v_add_f32 v112, v112, v119
v_add_f32 v112, v112, v120
v_add_f32 v112, v112, v121
v_add_u32 v122, 139776, v122
ds_write_b32 v122, v112
l2_kernel_nocs2:
s_waitcnt lgkmcnt(4)
v_mfma_f32_32x32x16_bf16 v[80:95], v[52:55], a[88:91], v[80:95]
ds_read_b128 v[40:43], v1 offset:25600
buffer_load_dwordx4 v1, s[8:11], s4 offen offset:1024  lds
buffer_load_dwordx4 a[132:135], v1, s[8:11], s38 offen offset:1024 sc1
s_waitcnt vmcnt(13)
s_waitcnt lgkmcnt(4)
v_mfma_f32_32x32x16_bf16 v[64:79], v[56:59], a[92:95], v[64:79]
ds_read_b128 v[44:47], v30 offset:5120
s_waitcnt lgkmcnt(4)
v_mfma_f32_32x32x16_bf16 v[80:95], v[60:63], a[92:95], v[80:95]
ds_read_b128 v[48:51], v1 offset:26624
buffer_load_dwordx4 a[136:139], v1, s[8:11], s38 offen offset:2048 sc1
s_waitcnt vmcnt(13)
s_waitcnt lgkmcnt(4)
v_mfma_f32_32x32x16_bf16 v[64:79], v[32:35], a[96:99], v[64:79]
ds_read_b128 v[52:55], v30 offset:6144
buffer_load_dwordx4 v1, s[8:11], s4 offen offset:2048  lds
s_waitcnt lgkmcnt(4)
v_mfma_f32_32x32x16_bf16 v[80:95], v[36:39], a[96:99], v[80:95]
ds_read_b128 v[56:59], v1 offset:27648
buffer_load_dwordx4 a[140:143], v1, s[8:11], s38 offen offset:3072 sc1
s_waitcnt vmcnt(14)
s_waitcnt lgkmcnt(4)
v_mfma_f32_32x32x16_bf16 v[64:79], v[40:43], a[100:103], v[64:79]
ds_read_b128 v[60:63], v30 offset:7168
buffer_load_dwordx4 v[148:151], v31, s[8:11], s55 offen
s_waitcnt lgkmcnt(4)
v_mfma_f32_32x32x16_bf16 v[80:95], v[44:47], a[100:103], v[80:95]
ds_read_b128 v[32:35], v1 offset:28672
buffer_load_dwordx4 v1, s[8:11], s4 offen offset:3072  lds
s_add_u32 s38, s38, 4096
buffer_load_dwordx4 a[144:147], v1, s[8:11], s38 offen offset:0 sc1
s_waitcnt vmcnt(16)
s_waitcnt lgkmcnt(4)
v_mfma_f32_32x32x16_bf16 v[64:79], v[48:51], a[104:107], v[64:79]
ds_read_b128 v[36:39], v30 offset:8192
s_waitcnt lgkmcnt(4)
v_mfma_f32_32x32x16_bf16 v[80:95], v[52:55], a[104:107], v[80:95]
ds_read_b128 v[40:43], v1 offset:29696
buffer_load_dwordx4 a[148:151], v1, s[8:11], s38 offen offset:1024 sc1
s_waitcnt vmcnt(16)
s_waitcnt lgkmcnt(4)
v_mfma_f32_32x32x16_bf16 v[64:79], v[56:59], a[108:111], v[64:79]
ds_read_b128 v[44:47], v30 offset:9216
s_add_u32 s4, s4, 4096
s_add_u32 m0, m0, 4096
s_nop 0
buffer_load_dwordx4 v1, s[8:11], s4 offen  lds
s_waitcnt lgkmcnt(4)
v_mfma_f32_32x32x16_bf16 v[80:95], v[60:63], a[108:111], v[80:95]
ds_read_b128 v[48:51], v1 offset:30720
buffer_load_dwordx4 a[152:155], v1, s[8:11], s38 offen offset:2048 sc1
s_waitcnt vmcnt(17)
s_waitcnt lgkmcnt(4)
v_mfma_f32_32x32x16_bf16 v[64:79], v[32:35], a[112:115], v[64:79]
ds_read_b128 v[52:55], v30 offset:10240
s_mul_i32 s5, s46, 5120
v_add_u32 v31, s5, v1
buffer_load_dwordx4 v[152:155], v31, s[8:11], s54 offen offset:0
s_waitcnt lgkmcnt(4)
v_mfma_f32_32x32x16_bf16 v[80:95], v[36:39], a[112:115], v[80:95]
ds_read_b128 v[56:59], v1 offset:31744
s_add_u32 s4, s34, s35
s_add_u32 s4, s4, 143360
s_add_u32 m0, s34, 40960
s_nop 0
buffer_load_dwordx4 v1, s[8:11], s4 offen  lds
buffer_load_dwordx4 a[156:159], v1, s[8:11], s38 offen offset:3072 sc1
s_waitcnt vmcnt(19)
s_waitcnt lgkmcnt(4)
v_mfma_f32_32x32x16_bf16 v[64:79], v[40:43], a[116:119], v[64:79]
ds_read_b128 v[60:63], v30 offset:11264
s_waitcnt lgkmcnt(4)
v_mfma_f32_32x32x16_bf16 v[80:95], v[44:47], a[116:119], v[80:95]
ds_read_b128 v[32:35], v1 offset:32768
s_waitcnt vmcnt(18)
s_waitcnt lgkmcnt(4)
v_mfma_f32_32x32x16_bf16 v[64:79], v[48:51], a[120:123], v[64:79]
ds_read_b128 v[36:39], v30 offset:12288
buffer_load_dwordx4 v1, s[8:11], s4 offen offset:1024  lds
s_waitcnt lgkmcnt(4)
v_mfma_f32_32x32x16_bf16 v[80:95], v[52:55], a[120:123], v[80:95]
ds_read_b128 v[40:43], v1 offset:33792
s_waitcnt vmcnt(18)
s_waitcnt lgkmcnt(4)
v_mfma_f32_32x32x16_bf16 v[64:79], v[56:59], a[124:127], v[64:79]
ds_read_b128 v[44:47], v30 offset:13312
buffer_load_dwordx4 v[156:159], v31, s[8:11], s54 offen offset:1024
s_waitcnt lgkmcnt(4)
v_mfma_f32_32x32x16_bf16 v[80:95], v[60:63], a[124:127], v[80:95]
ds_read_b128 v[48:51], v1 offset:34816
buffer_load_dwordx4 v1, s[8:11], s4 offen offset:2048  lds
s_waitcnt vmcnt(18)
s_waitcnt lgkmcnt(4)
v_mfma_f32_32x32x16_bf16 v[64:79], v[32:35], a[128:131], v[64:79]
ds_read_b128 v[52:55], v30 offset:14336
s_waitcnt lgkmcnt(4)
v_mfma_f32_32x32x16_bf16 v[80:95], v[36:39], a[128:131], v[80:95]
ds_read_b128 v[56:59], v1 offset:35840
s_waitcnt vmcnt(15)
s_waitcnt lgkmcnt(4)
v_mfma_f32_32x32x16_bf16 v[64:79], v[40:43], a[132:135], v[64:79]
ds_read_b128 v[60:63], v30 offset:15360
buffer_load_dwordx4 v1, s[8:11], s4 offen offset:3072  lds
s_waitcnt lgkmcnt(4)
v_mfma_f32_32x32x16_bf16 v[80:95], v[44:47], a[132:135], v[80:95]
ds_read_b128 v[32:35], v1 offset:36864
s_waitcnt vmcnt(15)
s_waitcnt lgkmcnt(4)
v_mfma_f32_32x32x16_bf16 v[64:79], v[48:51], a[136:139], v[64:79]
ds_read_b128 v[36:39], v30 offset:16384
buffer_load_dwordx4 v[160:163], v31, s[8:11], s54 offen offset:2048
s_waitcnt lgkmcnt(4)
v_mfma_f32_32x32x16_bf16 v[80:95], v[52:55], a[136:139], v[80:95]
ds_read_b128 v[40:43], v1 offset:37888
s_add_u32 s4, s4, 4096
s_add_u32 m0, m0, 4096
s_nop 0
buffer_load_dwordx4 v1, s[8:11], s4 offen  lds
s_waitcnt vmcnt(15)
s_waitcnt lgkmcnt(4)
v_mfma_f32_32x32x16_bf16 v[64:79], v[56:59], a[140:143], v[64:79]
ds_read_b128 v[44:47], v30 offset:17408
s_waitcnt lgkmcnt(4)
v_mfma_f32_32x32x16_bf16 v[80:95], v[60:63], a[140:143], v[80:95]
ds_read_b128 v[48:51], v1 offset:38912
s_waitcnt vmcnt(12)
s_waitcnt lgkmcnt(4)
v_mfma_f32_32x32x16_bf16 v[64:79], v[32:35], a[144:147], v[64:79]
ds_read_b128 v[52:55], v30 offset:18432
s_waitcnt lgkmcnt(4)
v_mfma_f32_32x32x16_bf16 v[80:95], v[36:39], a[144:147], v[80:95]
ds_read_b128 v[56:59], v1 offset:39936
s_waitcnt vmcnt(11)
s_waitcnt lgkmcnt(4)
v_mfma_f32_32x32x16_bf16 v[64:79], v[40:43], a[148:151], v[64:79]
ds_read_b128 v[60:63], v30 offset:19456
buffer_load_dwordx4 v[164:167], v31, s[8:11], s54 offen offset:3072
s_waitcnt lgkmcnt(4)
v_mfma_f32_32x32x16_bf16 v[80:95], v[44:47], a[148:151], v[80:95]
ds_read_b128 v[32:35], v30 offset:20480
s_waitcnt vmcnt(10)
s_waitcnt lgkmcnt(4)
v_mfma_f32_32x32x16_bf16 v[64:79], v[48:51], a[152:155], v[64:79]
ds_read_b128 v[36:39], v30 offset:21504
s_waitcnt lgkmcnt(4)
v_mfma_f32_32x32x16_bf16 v[80:95], v[52:55], a[152:155], v[80:95]
ds_read_b128 v[40:43], v30 offset:22528
s_waitcnt vmcnt(7)
s_waitcnt lgkmcnt(4)
v_mfma_f32_32x32x16_bf16 v[64:79], v[56:59], a[156:159], v[64:79]
ds_read_b128 v[44:47], v30 offset:23552
s_waitcnt lgkmcnt(4)
v_mfma_f32_32x32x16_bf16 v[80:95], v[60:63], a[156:159], v[80:95]
ds_read_b128 v[48:51], v30 offset:24576
s_barrier
s_waitcnt lgkmcnt(4)
v_mfma_f32_32x32x16_bf16 v[96:111], v[32:35], a[0:3], 0
ds_read_b128 v[52:55], v30 offset:25600
buffer_load_dwordx4 v[168:171], v31, s[8:11], s55 offen
s_waitcnt lgkmcnt(4)
v_mfma_f32_32x32x16_bf16 v[96:111], v[36:39], a[4:7], v[96:111]
ds_read_b128 v[56:59], v30 offset:26624
s_add_u32 s4, s34, s35
s_add_u32 s4, s4, 163840
s_add_u32 m0, s34, 20480
s_nop 0
buffer_load_dwordx4 v1, s[8:11], s4 offen  lds
s_waitcnt lgkmcnt(4)
v_mfma_f32_32x32x16_bf16 v[96:111], v[40:43], a[8:11], v[96:111]
ds_read_b128 v[60:63], v30 offset:27648
ds_read_b128 v[112:115], v9 offset:0
ds_read_b128 v[116:119], v9 offset:16
ds_read_b128 v[120:123], v9 offset:32
ds_read_b128 v[124:127], v9 offset:48
s_waitcnt lgkmcnt(8)
v_mfma_f32_32x32x16_bf16 v[96:111], v[44:47], a[12:15], v[96:111]
ds_read_b128 v[32:35], v30 offset:28672
s_waitcnt lgkmcnt(1)
v_mul_f32 v112, v7, v112
v_mul_f32 v113, v7, v113
v_mul_f32 v114, v7, v114
v_mfma_f32_32x32x16_bf16 v[96:111], v[48:51], a[16:19], v[96:111]
ds_read_b128 v[36:39], v30 offset:29696
v_mul_f32 v115, v7, v115
v_mul_f32 v116, v7, v116
v_mul_f32 v117, v7, v117
v_mul_f32 v118, v7, v118
buffer_load_dwordx4 v1, s[8:11], s4 offen offset:1024  lds
v_mfma_f32_32x32x16_bf16 v[96:111], v[52:55], a[20:23], v[96:111]
ds_read_b128 v[40:43], v30 offset:30720
v_mul_f32 v119, v7, v119
v_mul_f32 v120, v5, v120
v_mul_f32 v121, v5, v121
v_mul_f32 v122, v5, v122
v_mfma_f32_32x32x16_bf16 v[96:111], v[56:59], a[24:27], v[96:111]
ds_read_b128 v[44:47], v30 offset:31744
v_mul_f32 v123, v5, v123
v_mul_f32 v124, v5, v124
v_mul_f32 v125, v5, v125
v_mul_f32 v126, v5, v126
s_mul_i32 s5, s47, 5120
v_add_u32 v31, s5, v1
buffer_load_dwordx4 v[172:175], v31, s[8:11], s54 offen offset:0
v_mfma_f32_32x32x16_bf16 v[96:111], v[60:63], a[28:31], v[96:111]
ds_read_b128 v[48:51], v30 offset:32768
v_mul_f32 v127, v5, v127
v_fma_f32 v64, v64, v6, v112
v_fma_f32 v65, v65, v6, v113
v_fma_f32 v66, v66, v6, v114
buffer_load_dwordx4 v1, s[8:11], s4 offen offset:2048  lds
s_waitcnt lgkmcnt(4)
v_mfma_f32_32x32x16_bf16 v[96:111], v[32:35], a[32:35], v[96:111]
ds_read_b128 v[52:55], v30 offset:33792
v_fma_f32 v67, v67, v6, v115
v_fma_f32 v68, v68, v6, v116
v_fma_f32 v69, v69, v6, v117
v_fma_f32 v70, v70, v6, v118
s_waitcnt lgkmcnt(4)
v_mfma_f32_32x32x16_bf16 v[96:111], v[36:39], a[36:39], v[96:111]
ds_read_b128 v[56:59], v30 offset:34816
v_fma_f32 v71, v71, v6, v119
v_exp_f32 v64, v64
v_fma_f32 v72, v72, v4, v120
v_exp_f32 v65, v65
s_waitcnt lgkmcnt(4)
v_mfma_f32_32x32x16_bf16 v[96:111], v[40:43], a[40:43], v[96:111]
ds_read_b128 v[60:63], v30 offset:35840
v_fma_f32 v73, v73, v4, v121
v_exp_f32 v66, v66
v_fma_f32 v74, v74, v4, v122
v_exp_f32 v67, v67
buffer_load_dwordx4 v1, s[8:11], s4 offen offset:3072  lds
s_waitcnt lgkmcnt(4)
v_mfma_f32_32x32x16_bf16 v[96:111], v[44:47], a[44:47], v[96:111]
ds_read_b128 v[32:35], v30 offset:36864
v_fma_f32 v75, v75, v4, v123
v_exp_f32 v68, v68
v_fma_f32 v76, v76, v4, v124
v_exp_f32 v69, v69
s_waitcnt lgkmcnt(4)
v_mfma_f32_32x32x16_bf16 v[96:111], v[48:51], a[48:51], v[96:111]
ds_read_b128 v[36:39], v30 offset:37888
v_fma_f32 v77, v77, v4, v125
v_exp_f32 v70, v70
v_fma_f32 v78, v78, v4, v126
v_exp_f32 v71, v71
buffer_load_dwordx4 v[176:179], v31, s[8:11], s54 offen offset:1024
s_waitcnt lgkmcnt(4)
v_mfma_f32_32x32x16_bf16 v[96:111], v[52:55], a[52:55], v[96:111]
ds_read_b128 v[40:43], v30 offset:38912
v_fma_f32 v79, v79, v4, v127
v_add_f32 v64, 1.0, v64
v_add_f32 v65, 1.0, v65
v_add_f32 v66, 1.0, v66
s_add_u32 s4, s4, 4096
s_add_u32 m0, m0, 4096
s_nop 0
buffer_load_dwordx4 v1, s[8:11], s4 offen  lds
s_waitcnt lgkmcnt(4)
v_mfma_f32_32x32x16_bf16 v[96:111], v[56:59], a[56:59], v[96:111]
ds_read_b128 v[44:47], v30 offset:39936
v_add_f32 v67, 1.0, v67
v_add_f32 v68, 1.0, v68
v_add_f32 v69, 1.0, v69
v_add_f32 v70, 1.0, v70
s_waitcnt lgkmcnt(4)
v_mfma_f32_32x32x16_bf16 v[96:111], v[60:63], a[60:63], v[96:111]
ds_read_b128 v[48:51], v30 offset:40960
v_add_f32 v71, 1.0, v71
v_rcp_f32 v64, v64
v_rcp_f32 v65, v65
v_rcp_f32 v66, v66
s_waitcnt lgkmcnt(4)
v_mfma_f32_32x32x16_bf16 v[96:111], v[32:35], a[64:67], v[96:111]
ds_read_b128 v[52:55], v30 offset:41984
v_rcp_f32 v67, v67
v_rcp_f32 v68, v68
v_rcp_f32 v69, v69
v_rcp_f32 v70, v70
s_add_u32 s4, s34, s35
s_add_u32 s4, s4, 184320
s_add_u32 m0, s34, 61440
s_nop 0
buffer_load_dwordx4 v1, s[8:11], s4 offen  lds
s_waitcnt lgkmcnt(4)
v_mfma_f32_32x32x16_bf16 v[96:111], v[36:39], a[68:71], v[96:111]
ds_read_b128 v[56:59], v30 offset:43008
v_rcp_f32 v71, v71
v_mul_f32 v64, v64, v72
v_mul_f32 v65, v65, v73
v_mul_f32 v66, v66, v74
s_waitcnt lgkmcnt(4)
v_mfma_f32_32x32x16_bf16 v[96:111], v[40:43], a[72:75], v[96:111]
ds_read_b128 v[60:63], v30 offset:44032
v_mul_f32 v67, v67, v75
v_mul_f32 v68, v68, v76
v_mul_f32 v69, v69, v77
v_mul_f32 v70, v70, v78
buffer_load_dwordx4 v[180:183], v31, s[8:11], s54 offen offset:2048
s_waitcnt lgkmcnt(4)
v_mfma_f32_32x32x16_bf16 v[96:111], v[44:47], a[76:79], v[96:111]
ds_read_b128 v[32:35], v30 offset:45056
v_mul_f32 v71, v71, v79
v_cvt_pk_bf16_f32 v18, v64, v65
v_cvt_pk_bf16_f32 v19, v66, v67
v_cvt_pk_bf16_f32 v20, v68, v69
buffer_load_dwordx4 v1, s[8:11], s4 offen offset:1024  lds
s_barrier
s_waitcnt lgkmcnt(4)
v_mfma_f32_32x32x16_bf16 v[96:111], v[48:51], a[80:83], v[96:111]
ds_read_b128 v[36:39], v30 offset:46080
v_cvt_pk_bf16_f32 v21, v70, v71
buffer_store_dwordx4 v[18:21], v8, s[8:11], s36 offen sc1
s_add_u32 s36, s36, 512
ds_read_b128 v[112:115], v9 offset:128
s_waitcnt lgkmcnt(5)
v_mfma_f32_32x32x16_bf16 v[96:111], v[52:55], a[84:87], v[96:111]
ds_read_b128 v[40:43], v30 offset:47104
ds_read_b128 v[116:119], v9 offset:144
ds_read_b128 v[120:123], v9 offset:160
ds_read_b128 v[124:127], v9 offset:176
s_waitcnt lgkmcnt(0)
v_mfma_f32_32x32x16_bf16 v[96:111], v[56:59], a[88:91], v[96:111]
ds_read_b128 v[44:47], v30 offset:48128
v_mul_f32 v112, v7, v112
v_mul_f32 v113, v7, v113
v_mul_f32 v114, v7, v114
v_mul_f32 v115, v7, v115
buffer_load_dwordx4 v1, s[8:11], s4 offen offset:2048  lds
v_mfma_f32_32x32x16_bf16 v[96:111], v[60:63], a[92:95], v[96:111]
ds_read_b128 v[48:51], v30 offset:49152
v_mul_f32 v116, v7, v116
v_mul_f32 v117, v7, v117
v_mul_f32 v118, v7, v118
v_mul_f32 v119, v7, v119
v_mfma_f32_32x32x16_bf16 v[96:111], v[32:35], a[96:99], v[96:111]
ds_read_b128 v[52:55], v30 offset:50176
v_mul_f32 v120, v5, v120
v_mul_f32 v121, v5, v121
v_mul_f32 v122, v5, v122
v_mul_f32 v123, v5, v123
buffer_load_dwordx4 v[184:187], v31, s[8:11], s54 offen offset:3072
v_mfma_f32_32x32x16_bf16 v[96:111], v[36:39], a[100:103], v[96:111]
ds_read_b128 v[56:59], v30 offset:51200
v_mul_f32 v124, v5, v124
v_mul_f32 v125, v5, v125
v_mul_f32 v126, v5, v126
v_mul_f32 v127, v5, v127
buffer_load_dwordx4 v1, s[8:11], s4 offen offset:3072  lds
v_mfma_f32_32x32x16_bf16 v[96:111], v[40:43], a[104:107], v[96:111]
ds_read_b128 v[60:63], v30 offset:52224
v_fma_f32 v80, v80, v6, v112
v_fma_f32 v81, v81, v6, v113
v_fma_f32 v82, v82, v6, v114
v_fma_f32 v83, v83, v6, v115
s_waitcnt lgkmcnt(4)
v_mfma_f32_32x32x16_bf16 v[96:111], v[44:47], a[108:111], v[96:111]
ds_read_b128 v[32:35], v30 offset:53248
v_fma_f32 v84, v84, v6, v116
v_fma_f32 v85, v85, v6, v117
v_fma_f32 v86, v86, v6, v118
v_fma_f32 v87, v87, v6, v119
s_waitcnt lgkmcnt(4)
v_mfma_f32_32x32x16_bf16 v[96:111], v[48:51], a[112:115], v[96:111]
ds_read_b128 v[36:39], v30 offset:54272
v_exp_f32 v80, v80
v_fma_f32 v88, v88, v4, v120
v_exp_f32 v81, v81
v_fma_f32 v89, v89, v4, v121
s_add_u32 s4, s4, 4096
s_add_u32 m0, m0, 4096
s_nop 0
buffer_load_dwordx4 v1, s[8:11], s4 offen  lds
s_waitcnt lgkmcnt(4)
v_mfma_f32_32x32x16_bf16 v[96:111], v[52:55], a[116:119], v[96:111]
ds_read_b128 v[40:43], v30 offset:55296
v_exp_f32 v82, v82
v_fma_f32 v90, v90, v4, v122
v_exp_f32 v83, v83
v_fma_f32 v91, v91, v4, v123
s_waitcnt lgkmcnt(4)
v_mfma_f32_32x32x16_bf16 v[96:111], v[56:59], a[120:123], v[96:111]
ds_read_b128 v[44:47], v30 offset:56320
v_exp_f32 v84, v84
v_fma_f32 v92, v92, v4, v124
v_exp_f32 v85, v85
v_fma_f32 v93, v93, v4, v125
buffer_load_dwordx4 v[188:191], v31, s[8:11], s55 offen
s_waitcnt lgkmcnt(4)
v_mfma_f32_32x32x16_bf16 v[96:111], v[60:63], a[124:127], v[96:111]
ds_read_b128 v[48:51], v30 offset:57344
v_exp_f32 v86, v86
v_fma_f32 v94, v94, v4, v126
v_exp_f32 v87, v87
v_fma_f32 v95, v95, v4, v127
s_add_u32 s4, s34, s35
s_add_u32 s4, s4, 204800
s_add_u32 m0, s34, 81920
s_nop 0
buffer_load_dwordx4 v1, s[8:11], s4 offen  lds
s_waitcnt lgkmcnt(4)
v_mfma_f32_32x32x16_bf16 v[96:111], v[32:35], a[128:131], v[96:111]
ds_read_b128 v[52:55], v30 offset:58368
v_add_f32 v80, 1.0, v80
v_add_f32 v81, 1.0, v81
v_add_f32 v82, 1.0, v82
v_add_f32 v83, 1.0, v83
s_waitcnt lgkmcnt(4)
v_mfma_f32_32x32x16_bf16 v[96:111], v[36:39], a[132:135], v[96:111]
ds_read_b128 v[56:59], v30 offset:59392
v_add_f32 v84, 1.0, v84
v_add_f32 v85, 1.0, v85
v_add_f32 v86, 1.0, v86
v_add_f32 v87, 1.0, v87
s_waitcnt lgkmcnt(4)
v_mfma_f32_32x32x16_bf16 v[96:111], v[40:43], a[136:139], v[96:111]
ds_read_b128 v[60:63], v30 offset:60416
v_rcp_f32 v80, v80
v_rcp_f32 v81, v81
v_rcp_f32 v82, v82
v_rcp_f32 v83, v83
buffer_load_dwordx4 v1, s[8:11], s4 offen offset:1024  lds
s_waitcnt lgkmcnt(4)
v_mfma_f32_32x32x16_bf16 v[96:111], v[44:47], a[140:143], v[96:111]
ds_read_b128 v[32:35], v1 offset:0
v_rcp_f32 v84, v84
v_rcp_f32 v85, v85
v_rcp_f32 v86, v86
v_rcp_f32 v87, v87
s_waitcnt lgkmcnt(4)
v_mfma_f32_32x32x16_bf16 v[96:111], v[48:51], a[144:147], v[96:111]
ds_read_b128 v[36:39], v1 offset:1024
v_mul_f32 v80, v80, v88
v_mul_f32 v81, v81, v89
v_mul_f32 v82, v82, v90
v_mul_f32 v83, v83, v91
v_mul_f32 v84, v84, v92
v_mul_f32 v85, v85, v93
v_mul_f32 v86, v86, v94
v_mul_f32 v87, v87, v95
s_mul_i32 s5, s48, 5120
v_add_u32 v31, s5, v1
buffer_load_dwordx4 v[192:195], v31, s[8:11], s54 offen offset:0
s_waitcnt lgkmcnt(4)
v_mfma_f32_32x32x16_bf16 v[96:111], v[52:55], a[148:151], v[96:111]
ds_read_b128 v[40:43], v1 offset:2048
v_cvt_pk_bf16_f32 v18, v80, v81
v_cvt_pk_bf16_f32 v19, v82, v83
v_cvt_pk_bf16_f32 v20, v84, v85
v_cvt_pk_bf16_f32 v21, v86, v87
buffer_store_dwordx4 v[18:21], v8, s[8:11], s36 offen sc1
s_add_u32 s36, s36, 512
buffer_load_dwordx4 v1, s[8:11], s4 offen offset:2048  lds
s_waitcnt lgkmcnt(4)
v_mfma_f32_32x32x16_bf16 v[96:111], v[56:59], a[152:155], v[96:111]
ds_read_b128 v[44:47], v1 offset:3072
s_waitcnt lgkmcnt(4)
v_mfma_f32_32x32x16_bf16 v[96:111], v[60:63], a[156:159], v[96:111]
ds_read_b128 v[48:51], v1 offset:4096
s_waitcnt vmcnt(23)
s_barrier
s_waitcnt lgkmcnt(4)
v_mfma_f32_32x32x16_bf16 v[64:79], v[32:35], a[0:3], 0
ds_read_b128 v[52:55], v1 offset:5120
buffer_load_dwordx4 v1, s[8:11], s4 offen offset:3072  lds
s_waitcnt lgkmcnt(4)
v_mfma_f32_32x32x16_bf16 v[64:79], v[36:39], a[4:7], v[64:79]
ds_read_b128 v[56:59], v1 offset:6144
s_waitcnt lgkmcnt(4)
v_mfma_f32_32x32x16_bf16 v[64:79], v[40:43], a[8:11], v[64:79]
ds_read_b128 v[60:63], v1 offset:7168
ds_read_b128 v[112:115], v9 offset:256
ds_read_b128 v[116:119], v9 offset:272
buffer_load_dwordx4 v[196:199], v31, s[8:11], s54 offen offset:1024
s_waitcnt lgkmcnt(6)
v_mfma_f32_32x32x16_bf16 v[64:79], v[44:47], a[12:15], v[64:79]
ds_read_b128 v[32:35], v1 offset:8192
ds_read_b128 v[120:123], v9 offset:288
ds_read_b128 v[124:127], v9 offset:304
s_add_u32 s4, s4, 4096
s_add_u32 m0, m0, 4096
s_nop 0
buffer_load_dwordx4 v1, s[8:11], s4 offen  lds
s_waitcnt lgkmcnt(8)
v_mfma_f32_32x32x16_bf16 v[64:79], v[48:51], a[16:19], v[64:79]
ds_read_b128 v[36:39], v1 offset:9216
s_waitcnt lgkmcnt(1)
v_mul_f32 v112, v7, v112
v_mfma_f32_32x32x16_bf16 v[64:79], v[52:55], a[20:23], v[64:79]
ds_read_b128 v[40:43], v1 offset:10240
v_mul_f32 v113, v7, v113
v_mul_f32 v114, v7, v114
v_mfma_f32_32x32x16_bf16 v[64:79], v[56:59], a[24:27], v[64:79]
ds_read_b128 v[44:47], v1 offset:11264
v_mul_f32 v115, v7, v115
v_mul_f32 v116, v7, v116
s_add_u32 s4, s34, s35
s_add_u32 s4, s4, 225280
s_add_u32 m0, s34, 102400
s_nop 0
buffer_load_dwordx4 v1, s[8:11], s4 offen  lds
v_mfma_f32_32x32x16_bf16 v[64:79], v[60:63], a[28:31], v[64:79]
ds_read_b128 v[48:51], v1 offset:12288
v_mul_f32 v117, v7, v117
v_mul_f32 v118, v7, v118
v_mfma_f32_32x32x16_bf16 v[64:79], v[32:35], a[32:35], v[64:79]
ds_read_b128 v[52:55], v1 offset:13312
v_mul_f32 v119, v7, v119
v_mul_f32 v120, v5, v120
buffer_load_dwordx4 v[200:203], v31, s[8:11], s54 offen offset:2048
s_waitcnt lgkmcnt(4)
v_mfma_f32_32x32x16_bf16 v[64:79], v[36:39], a[36:39], v[64:79]
ds_read_b128 v[56:59], v1 offset:14336
v_mul_f32 v121, v5, v121
v_mul_f32 v122, v5, v122
buffer_load_dwordx4 v1, s[8:11], s4 offen offset:1024  lds
s_waitcnt lgkmcnt(4)
v_mfma_f32_32x32x16_bf16 v[64:79], v[40:43], a[40:43], v[64:79]
ds_read_b128 v[60:63], v1 offset:15360
v_mul_f32 v123, v5, v123
v_mul_f32 v124, v5, v124
s_waitcnt lgkmcnt(4)
v_mfma_f32_32x32x16_bf16 v[64:79], v[44:47], a[44:47], v[64:79]
ds_read_b128 v[32:35], v1 offset:16384
v_mul_f32 v125, v5, v125
v_mul_f32 v126, v5, v126
s_waitcnt lgkmcnt(4)
v_mfma_f32_32x32x16_bf16 v[64:79], v[48:51], a[48:51], v[64:79]
ds_read_b128 v[36:39], v1 offset:17408
v_mul_f32 v127, v5, v127
v_fma_f32 v96, v96, v6, v112
buffer_load_dwordx4 v1, s[8:11], s4 offen offset:2048  lds
s_waitcnt lgkmcnt(4)
v_mfma_f32_32x32x16_bf16 v[64:79], v[52:55], a[52:55], v[64:79]
ds_read_b128 v[40:43], v1 offset:18432
v_fma_f32 v97, v97, v6, v113
v_fma_f32 v98, v98, v6, v114
s_waitcnt lgkmcnt(4)
v_mfma_f32_32x32x16_bf16 v[64:79], v[56:59], a[56:59], v[64:79]
ds_read_b128 v[44:47], v1 offset:19456
v_fma_f32 v99, v99, v6, v115
v_fma_f32 v100, v100, v6, v116
buffer_load_dwordx4 v[204:207], v31, s[8:11], s54 offen offset:3072
s_waitcnt lgkmcnt(4)
v_mfma_f32_32x32x16_bf16 v[64:79], v[60:63], a[60:63], v[64:79]
ds_read_b128 v[48:51], v1 offset:40960
v_fma_f32 v101, v101, v6, v117
v_fma_f32 v102, v102, v6, v118
buffer_load_dwordx4 v1, s[8:11], s4 offen offset:3072  lds
s_waitcnt lgkmcnt(4)
v_mfma_f32_32x32x16_bf16 v[64:79], v[32:35], a[64:67], v[64:79]
ds_read_b128 v[52:55], v1 offset:41984
v_fma_f32 v103, v103, v6, v119
v_exp_f32 v96, v96
s_waitcnt lgkmcnt(4)
v_mfma_f32_32x32x16_bf16 v[64:79], v[36:39], a[68:71], v[64:79]
ds_read_b128 v[56:59], v1 offset:43008
v_fma_f32 v104, v104, v4, v120
v_exp_f32 v97, v97
s_waitcnt lgkmcnt(4)
v_mfma_f32_32x32x16_bf16 v[64:79], v[40:43], a[72:75], v[64:79]
ds_read_b128 v[60:63], v1 offset:44032
v_fma_f32 v105, v105, v4, v121
v_exp_f32 v98, v98
s_add_u32 s4, s4, 4096
s_add_u32 m0, m0, 4096
s_nop 0
buffer_load_dwordx4 v1, s[8:11], s4 offen  lds
s_waitcnt lgkmcnt(4)
v_mfma_f32_32x32x16_bf16 v[64:79], v[44:47], a[76:79], v[64:79]
ds_read_b128 v[32:35], v1 offset:45056
v_fma_f32 v106, v106, v4, v122
v_exp_f32 v99, v99
s_waitcnt vmcnt(24)
s_barrier
s_waitcnt lgkmcnt(4)
v_mfma_f32_32x32x16_bf16 v[64:79], v[48:51], a[80:83], v[64:79]
ds_read_b128 v[36:39], v1 offset:46080
v_fma_f32 v107, v107, v4, v123
v_exp_f32 v100, v100
buffer_load_dwordx4 v[208:211], v31, s[8:11], s55 offen
s_waitcnt lgkmcnt(4)
v_mfma_f32_32x32x16_bf16 v[64:79], v[52:55], a[84:87], v[64:79]
ds_read_b128 v[40:43], v1 offset:47104
v_fma_f32 v108, v108, v4, v124
v_exp_f32 v101, v101
s_add_u32 s4, s34, s35
s_add_u32 s4, s4, 245760
s_add_u32 m0, s34, 0
s_nop 0
buffer_load_dwordx4 v1, s[8:11], s4 offen  lds
s_waitcnt lgkmcnt(4)
v_mfma_f32_32x32x16_bf16 v[64:79], v[56:59], a[88:91], v[64:79]
ds_read_b128 v[44:47], v1 offset:48128
v_fma_f32 v109, v109, v4, v125
v_exp_f32 v102, v102
s_waitcnt lgkmcnt(4)
v_mfma_f32_32x32x16_bf16 v[64:79], v[60:63], a[92:95], v[64:79]
ds_read_b128 v[48:51], v1 offset:49152
v_fma_f32 v110, v110, v4, v126
v_exp_f32 v103, v103
s_waitcnt lgkmcnt(4)
v_mfma_f32_32x32x16_bf16 v[64:79], v[32:35], a[96:99], v[64:79]
ds_read_b128 v[52:55], v1 offset:50176
v_fma_f32 v111, v111, v4, v127
v_add_f32 v96, 1.0, v96
buffer_load_dwordx4 v1, s[8:11], s4 offen offset:1024  lds
s_waitcnt lgkmcnt(4)
v_mfma_f32_32x32x16_bf16 v[64:79], v[36:39], a[100:103], v[64:79]
ds_read_b128 v[56:59], v1 offset:51200
v_add_f32 v97, 1.0, v97
v_add_f32 v98, 1.0, v98
s_waitcnt lgkmcnt(4)
v_mfma_f32_32x32x16_bf16 v[64:79], v[40:43], a[104:107], v[64:79]
ds_read_b128 v[60:63], v1 offset:52224
v_add_f32 v99, 1.0, v99
v_add_f32 v100, 1.0, v100
s_mul_i32 s5, s49, 5120
v_add_u32 v31, s5, v1
buffer_load_dwordx4 v[212:215], v31, s[8:11], s54 offen offset:0
s_waitcnt lgkmcnt(4)
v_mfma_f32_32x32x16_bf16 v[64:79], v[44:47], a[108:111], v[64:79]
ds_read_b128 v[32:35], v1 offset:53248
v_add_f32 v101, 1.0, v101
v_add_f32 v102, 1.0, v102
buffer_load_dwordx4 v1, s[8:11], s4 offen offset:2048  lds
s_waitcnt lgkmcnt(4)
v_mfma_f32_32x32x16_bf16 v[64:79], v[48:51], a[112:115], v[64:79]
ds_read_b128 v[36:39], v1 offset:54272
v_add_f32 v103, 1.0, v103
v_rcp_f32 v96, v96
s_waitcnt lgkmcnt(4)
v_mfma_f32_32x32x16_bf16 v[64:79], v[52:55], a[116:119], v[64:79]
ds_read_b128 v[40:43], v1 offset:55296
v_rcp_f32 v97, v97
v_rcp_f32 v98, v98
s_waitcnt lgkmcnt(4)
v_mfma_f32_32x32x16_bf16 v[64:79], v[56:59], a[120:123], v[64:79]
ds_read_b128 v[44:47], v1 offset:56320
v_rcp_f32 v99, v99
v_rcp_f32 v100, v100
buffer_load_dwordx4 v1, s[8:11], s4 offen offset:3072  lds
s_waitcnt lgkmcnt(4)
v_mfma_f32_32x32x16_bf16 v[64:79], v[60:63], a[124:127], v[64:79]
ds_read_b128 v[48:51], v1 offset:57344
v_rcp_f32 v101, v101
v_rcp_f32 v102, v102
s_waitcnt lgkmcnt(4)
v_mfma_f32_32x32x16_bf16 v[64:79], v[32:35], a[128:131], v[64:79]
ds_read_b128 v[52:55], v1 offset:58368
v_rcp_f32 v103, v103
v_mul_f32 v96, v96, v104
buffer_load_dwordx4 v[216:219], v31, s[8:11], s54 offen offset:1024
s_waitcnt lgkmcnt(4)
v_mfma_f32_32x32x16_bf16 v[64:79], v[36:39], a[132:135], v[64:79]
ds_read_b128 v[56:59], v1 offset:59392
v_mul_f32 v97, v97, v105
v_mul_f32 v98, v98, v106
s_add_u32 s4, s4, 4096
s_add_u32 m0, m0, 4096
s_nop 0
buffer_load_dwordx4 v1, s[8:11], s4 offen  lds
s_waitcnt lgkmcnt(4)
v_mfma_f32_32x32x16_bf16 v[64:79], v[40:43], a[136:139], v[64:79]
ds_read_b128 v[60:63], v1 offset:60416
v_mul_f32 v99, v99, v107
v_mul_f32 v100, v100, v108
s_waitcnt lgkmcnt(4)
v_mfma_f32_32x32x16_bf16 v[64:79], v[44:47], a[140:143], v[64:79]
ds_read_b128 v[32:35], v1 offset:20480
v_mul_f32 v101, v101, v109
v_mul_f32 v102, v102, v110
s_waitcnt lgkmcnt(4)
v_mfma_f32_32x32x16_bf16 v[64:79], v[48:51], a[144:147], v[64:79]
ds_read_b128 v[36:39], v1 offset:21504
v_mul_f32 v103, v103, v111
v_cvt_pk_bf16_f32 v18, v96, v97
v_cvt_pk_bf16_f32 v19, v98, v99
v_cvt_pk_bf16_f32 v20, v100, v101
v_cvt_pk_bf16_f32 v21, v102, v103
buffer_store_dwordx4 v[18:21], v8, s[8:11], s36 offen sc1
s_add_u32 s36, s36, 512
s_waitcnt lgkmcnt(4)
v_mfma_f32_32x32x16_bf16 v[64:79], v[52:55], a[148:151], v[64:79]
ds_read_b128 v[40:43], v1 offset:22528
s_waitcnt lgkmcnt(4)
v_mfma_f32_32x32x16_bf16 v[64:79], v[56:59], a[152:155], v[64:79]
ds_read_b128 v[44:47], v1 offset:23552
buffer_load_dwordx4 v[220:223], v31, s[8:11], s54 offen offset:2048
s_waitcnt lgkmcnt(4)
v_mfma_f32_32x32x16_bf16 v[64:79], v[60:63], a[156:159], v[64:79]
ds_read_b128 v[48:51], v1 offset:24576
s_waitcnt vmcnt(26)
s_barrier
s_waitcnt lgkmcnt(4)
v_mfma_f32_32x32x16_bf16 v[80:95], v[32:35], a[0:3], 0
ds_read_b128 v[52:55], v1 offset:25600
s_waitcnt lgkmcnt(4)
v_mfma_f32_32x32x16_bf16 v[80:95], v[36:39], a[4:7], v[80:95]
ds_read_b128 v[56:59], v1 offset:26624
s_waitcnt lgkmcnt(4)
v_mfma_f32_32x32x16_bf16 v[80:95], v[40:43], a[8:11], v[80:95]
ds_read_b128 v[60:63], v1 offset:27648
ds_read_b128 v[112:115], v9 offset:384
ds_read_b128 v[116:119], v9 offset:400
s_add_u32 s4, s34, s35
s_add_u32 s4, s4, 266240
s_add_u32 m0, s34, 40960
s_nop 0
buffer_load_dwordx4 v1, s[8:11], s4 offen  lds
s_waitcnt lgkmcnt(6)
v_mfma_f32_32x32x16_bf16 v[80:95], v[44:47], a[12:15], v[80:95]
ds_read_b128 v[32:35], v1 offset:28672
ds_read_b128 v[120:123], v9 offset:416
ds_read_b128 v[124:127], v9 offset:432
s_waitcnt lgkmcnt(8)
v_mfma_f32_32x32x16_bf16 v[80:95], v[48:51], a[16:19], v[80:95]
ds_read_b128 v[36:39], v1 offset:29696
s_waitcnt lgkmcnt(1)
v_mul_f32 v112, v7, v112
buffer_load_dwordx4 v[224:227], v31, s[8:11], s54 offen offset:3072
v_mfma_f32_32x32x16_bf16 v[80:95], v[52:55], a[20:23], v[80:95]
ds_read_b128 v[40:43], v1 offset:30720
v_mul_f32 v113, v7, v113
v_mul_f32 v114, v7, v114
buffer_load_dwordx4 v1, s[8:11], s4 offen offset:1024  lds
v_mfma_f32_32x32x16_bf16 v[80:95], v[56:59], a[24:27], v[80:95]
ds_read_b128 v[44:47], v1 offset:31744
v_mul_f32 v115, v7, v115
v_mul_f32 v116, v7, v116
v_mfma_f32_32x32x16_bf16 v[80:95], v[60:63], a[28:31], v[80:95]
ds_read_b128 v[48:51], v1 offset:32768
v_mul_f32 v117, v7, v117
v_mul_f32 v118, v7, v118
v_mfma_f32_32x32x16_bf16 v[80:95], v[32:35], a[32:35], v[80:95]
ds_read_b128 v[52:55], v1 offset:33792
v_mul_f32 v119, v7, v119
v_mul_f32 v120, v5, v120
buffer_load_dwordx4 v1, s[8:11], s4 offen offset:2048  lds
s_waitcnt lgkmcnt(4)
v_mfma_f32_32x32x16_bf16 v[80:95], v[36:39], a[36:39], v[80:95]
ds_read_b128 v[56:59], v1 offset:34816
v_mul_f32 v121, v5, v121
v_mul_f32 v122, v5, v122
s_waitcnt lgkmcnt(4)
v_mfma_f32_32x32x16_bf16 v[80:95], v[40:43], a[40:43], v[80:95]
ds_read_b128 v[60:63], v1 offset:35840
v_mul_f32 v123, v5, v123
v_mul_f32 v124, v5, v124
buffer_load_dwordx4 v[228:231], v31, s[8:11], s55 offen
s_waitcnt lgkmcnt(4)
v_mfma_f32_32x32x16_bf16 v[80:95], v[44:47], a[44:47], v[80:95]
ds_read_b128 v[32:35], v1 offset:36864
v_mul_f32 v125, v5, v125
v_mul_f32 v126, v5, v126
buffer_load_dwordx4 v1, s[8:11], s4 offen offset:3072  lds
s_waitcnt lgkmcnt(4)
v_mfma_f32_32x32x16_bf16 v[80:95], v[48:51], a[48:51], v[80:95]
ds_read_b128 v[36:39], v1 offset:37888
v_mul_f32 v127, v5, v127
v_fma_f32 v64, v64, v6, v112
s_waitcnt lgkmcnt(4)
v_mfma_f32_32x32x16_bf16 v[80:95], v[52:55], a[52:55], v[80:95]
ds_read_b128 v[40:43], v1 offset:38912
v_fma_f32 v65, v65, v6, v113
v_fma_f32 v66, v66, v6, v114
s_waitcnt lgkmcnt(4)
v_mfma_f32_32x32x16_bf16 v[80:95], v[56:59], a[56:59], v[80:95]
ds_read_b128 v[44:47], v1 offset:39936
v_fma_f32 v67, v67, v6, v115
v_fma_f32 v68, v68, v6, v116
s_add_u32 s4, s4, 4096
s_add_u32 m0, m0, 4096
s_nop 0
buffer_load_dwordx4 v1, s[8:11], s4 offen  lds
s_waitcnt lgkmcnt(4)
v_mfma_f32_32x32x16_bf16 v[80:95], v[60:63], a[60:63], v[80:95]
ds_read_b128 v[48:51], v1 offset:61440
v_fma_f32 v69, v69, v6, v117
v_fma_f32 v70, v70, v6, v118
s_waitcnt lgkmcnt(4)
v_mfma_f32_32x32x16_bf16 v[80:95], v[32:35], a[64:67], v[80:95]
ds_read_b128 v[52:55], v1 offset:62464
v_fma_f32 v71, v71, v6, v119
v_exp_f32 v64, v64
s_mul_i32 s5, s50, 5120
v_add_u32 v31, s5, v1
buffer_load_dwordx4 v[232:235], v31, s[8:11], s54 offen offset:0
s_waitcnt lgkmcnt(4)
v_mfma_f32_32x32x16_bf16 v[80:95], v[36:39], a[68:71], v[80:95]
ds_read_b128 v[56:59], v1 offset:63488
v_fma_f32 v72, v72, v4, v120
v_exp_f32 v65, v65
s_waitcnt lgkmcnt(4)
v_mfma_f32_32x32x16_bf16 v[80:95], v[40:43], a[72:75], v[80:95]
ds_read_b128 v[60:63], v1 offset:64512
v_fma_f32 v73, v73, v4, v121
v_exp_f32 v66, v66
s_waitcnt lgkmcnt(4)
v_mfma_f32_32x32x16_bf16 v[80:95], v[44:47], a[76:79], v[80:95]
ds_read_b128 v[32:35], v30 offset:4096
v_fma_f32 v74, v74, v4, v122
v_exp_f32 v67, v67
s_waitcnt vmcnt(25)
s_barrier
s_waitcnt lgkmcnt(4)
v_mfma_f32_32x32x16_bf16 v[80:95], v[48:51], a[80:83], v[80:95]
ds_read_b128 v[36:39], v30 offset:5120
v_fma_f32 v75, v75, v4, v123
v_exp_f32 v68, v68
s_waitcnt lgkmcnt(4)
v_mfma_f32_32x32x16_bf16 v[80:95], v[52:55], a[84:87], v[80:95]
ds_read_b128 v[40:43], v30 offset:6144
v_fma_f32 v76, v76, v4, v124
v_exp_f32 v69, v69
s_waitcnt lgkmcnt(4)
v_mfma_f32_32x32x16_bf16 v[80:95], v[56:59], a[88:91], v[80:95]
ds_read_b128 v[44:47], v30 offset:7168
v_fma_f32 v77, v77, v4, v125
v_exp_f32 v70, v70
buffer_load_dwordx4 v[236:239], v31, s[8:11], s54 offen offset:1024
s_waitcnt lgkmcnt(4)
v_mfma_f32_32x32x16_bf16 v[80:95], v[60:63], a[92:95], v[80:95]
ds_read_b128 v[48:51], v30 offset:8192
v_fma_f32 v78, v78, v4, v126
v_exp_f32 v71, v71
s_waitcnt lgkmcnt(4)
v_mfma_f32_32x32x16_bf16 v[80:95], v[32:35], a[96:99], v[80:95]
ds_read_b128 v[52:55], v30 offset:9216
v_fma_f32 v79, v79, v4, v127
v_add_f32 v64, 1.0, v64
s_waitcnt lgkmcnt(4)
v_mfma_f32_32x32x16_bf16 v[80:95], v[36:39], a[100:103], v[80:95]
ds_read_b128 v[56:59], v30 offset:10240
v_add_f32 v65, 1.0, v65
v_add_f32 v66, 1.0, v66
s_waitcnt lgkmcnt(4)
v_mfma_f32_32x32x16_bf16 v[80:95], v[40:43], a[104:107], v[80:95]
ds_read_b128 v[60:63], v30 offset:11264
v_add_f32 v67, 1.0, v67
v_add_f32 v68, 1.0, v68
s_waitcnt lgkmcnt(4)
v_mfma_f32_32x32x16_bf16 v[80:95], v[44:47], a[108:111], v[80:95]
ds_read_b128 v[32:35], v30 offset:12288
v_add_f32 v69, 1.0, v69
v_add_f32 v70, 1.0, v70
s_waitcnt lgkmcnt(4)
v_mfma_f32_32x32x16_bf16 v[80:95], v[48:51], a[112:115], v[80:95]
ds_read_b128 v[36:39], v30 offset:13312
v_add_f32 v71, 1.0, v71
v_rcp_f32 v64, v64
buffer_load_dwordx4 v[240:243], v31, s[8:11], s54 offen offset:2048
s_waitcnt lgkmcnt(4)
v_mfma_f32_32x32x16_bf16 v[80:95], v[52:55], a[116:119], v[80:95]
ds_read_b128 v[40:43], v30 offset:14336
v_rcp_f32 v65, v65
v_rcp_f32 v66, v66
s_waitcnt lgkmcnt(4)
v_mfma_f32_32x32x16_bf16 v[80:95], v[56:59], a[120:123], v[80:95]
ds_read_b128 v[44:47], v30 offset:15360
v_rcp_f32 v67, v67
v_rcp_f32 v68, v68
s_waitcnt lgkmcnt(4)
v_mfma_f32_32x32x16_bf16 v[80:95], v[60:63], a[124:127], v[80:95]
ds_read_b128 v[48:51], v30 offset:16384
v_rcp_f32 v69, v69
v_rcp_f32 v70, v70
s_waitcnt lgkmcnt(4)
v_mfma_f32_32x32x16_bf16 v[80:95], v[32:35], a[128:131], v[80:95]
ds_read_b128 v[52:55], v30 offset:17408
v_rcp_f32 v71, v71
v_mul_f32 v64, v64, v72
s_waitcnt lgkmcnt(4)
v_mfma_f32_32x32x16_bf16 v[80:95], v[36:39], a[132:135], v[80:95]
ds_read_b128 v[56:59], v30 offset:18432
v_mul_f32 v65, v65, v73
v_mul_f32 v66, v66, v74
s_waitcnt lgkmcnt(4)
v_mfma_f32_32x32x16_bf16 v[80:95], v[40:43], a[136:139], v[80:95]
ds_read_b128 v[60:63], v30 offset:19456
v_mul_f32 v67, v67, v75
v_mul_f32 v68, v68, v76
buffer_load_dwordx4 v[244:247], v31, s[8:11], s54 offen offset:3072
s_waitcnt lgkmcnt(4)
v_mfma_f32_32x32x16_bf16 v[80:95], v[44:47], a[140:143], v[80:95]
ds_read_b128 v[32:35], v30 offset:20480
v_mul_f32 v69, v69, v77
v_mul_f32 v70, v70, v78
s_waitcnt lgkmcnt(4)
v_mfma_f32_32x32x16_bf16 v[80:95], v[48:51], a[144:147], v[80:95]
ds_read_b128 v[36:39], v30 offset:21504
v_mul_f32 v71, v71, v79
v_cvt_pk_bf16_f32 v18, v64, v65
v_cvt_pk_bf16_f32 v19, v66, v67
v_cvt_pk_bf16_f32 v20, v68, v69
v_cvt_pk_bf16_f32 v21, v70, v71
buffer_store_dwordx4 v[18:21], v8, s[8:11], s36 offen sc1
s_add_u32 s36, s36, 512
s_waitcnt lgkmcnt(4)
v_mfma_f32_32x32x16_bf16 v[80:95], v[52:55], a[148:151], v[80:95]
ds_read_b128 v[40:43], v30 offset:22528
s_waitcnt lgkmcnt(4)
v_mfma_f32_32x32x16_bf16 v[80:95], v[56:59], a[152:155], v[80:95]
ds_read_b128 v[44:47], v30 offset:23552
s_waitcnt lgkmcnt(4)
v_mfma_f32_32x32x16_bf16 v[80:95], v[60:63], a[156:159], v[80:95]
ds_read_b128 v[48:51], v30 offset:24576
s_waitcnt vmcnt(22)
s_barrier
s_waitcnt lgkmcnt(4)
v_mfma_f32_32x32x16_bf16 v[96:111], v[32:35], a[0:3], 0
ds_read_b128 v[52:55], v30 offset:25600
buffer_load_dwordx4 v[248:251], v31, s[8:11], s55 offen
s_waitcnt lgkmcnt(4)
v_mfma_f32_32x32x16_bf16 v[96:111], v[36:39], a[4:7], v[96:111]
ds_read_b128 v[56:59], v30 offset:26624
s_waitcnt lgkmcnt(4)
v_mfma_f32_32x32x16_bf16 v[96:111], v[40:43], a[8:11], v[96:111]
ds_read_b128 v[60:63], v30 offset:27648
ds_read_b128 v[112:115], v9 offset:512
ds_read_b128 v[116:119], v9 offset:528
s_waitcnt lgkmcnt(6)
v_mfma_f32_32x32x16_bf16 v[96:111], v[44:47], a[12:15], v[96:111]
ds_read_b128 v[32:35], v30 offset:28672
ds_read_b128 v[120:123], v9 offset:544
ds_read_b128 v[124:127], v9 offset:560
s_waitcnt lgkmcnt(8)
v_mfma_f32_32x32x16_bf16 v[96:111], v[48:51], a[16:19], v[96:111]
ds_read_b128 v[36:39], v30 offset:29696
s_waitcnt lgkmcnt(1)
v_mul_f32 v112, v7, v112
v_mfma_f32_32x32x16_bf16 v[96:111], v[52:55], a[20:23], v[96:111]
ds_read_b128 v[40:43], v30 offset:30720
v_mul_f32 v113, v7, v113
v_mul_f32 v114, v7, v114
v_mfma_f32_32x32x16_bf16 v[96:111], v[56:59], a[24:27], v[96:111]
ds_read_b128 v[44:47], v30 offset:31744
v_mul_f32 v115, v7, v115
v_mul_f32 v116, v7, v116
s_mul_i32 s5, s51, 5120
v_add_u32 v31, s5, v1
buffer_load_dwordx4 v[252:255], v31, s[8:11], s54 offen offset:0
v_mfma_f32_32x32x16_bf16 v[96:111], v[60:63], a[28:31], v[96:111]
ds_read_b128 v[48:51], v30 offset:32768
v_mul_f32 v117, v7, v117
v_mul_f32 v118, v7, v118
v_mfma_f32_32x32x16_bf16 v[96:111], v[32:35], a[32:35], v[96:111]
ds_read_b128 v[52:55], v30 offset:33792
v_mul_f32 v119, v7, v119
v_mul_f32 v120, v5, v120
s_waitcnt lgkmcnt(4)
v_mfma_f32_32x32x16_bf16 v[96:111], v[36:39], a[36:39], v[96:111]
ds_read_b128 v[56:59], v30 offset:34816
v_mul_f32 v121, v5, v121
v_mul_f32 v122, v5, v122
s_waitcnt lgkmcnt(4)
v_mfma_f32_32x32x16_bf16 v[96:111], v[40:43], a[40:43], v[96:111]
ds_read_b128 v[60:63], v30 offset:35840
v_mul_f32 v123, v5, v123
v_mul_f32 v124, v5, v124
s_waitcnt lgkmcnt(4)
v_mfma_f32_32x32x16_bf16 v[96:111], v[44:47], a[44:47], v[96:111]
ds_read_b128 v[32:35], v30 offset:36864
v_mul_f32 v125, v5, v125
v_mul_f32 v126, v5, v126
s_waitcnt lgkmcnt(4)
v_mfma_f32_32x32x16_bf16 v[96:111], v[48:51], a[48:51], v[96:111]
ds_read_b128 v[36:39], v30 offset:37888
v_mul_f32 v127, v5, v127
v_fma_f32 v80, v80, v6, v112
s_waitcnt lgkmcnt(4)
v_mfma_f32_32x32x16_bf16 v[96:111], v[52:55], a[52:55], v[96:111]
ds_read_b128 v[40:43], v30 offset:38912
v_fma_f32 v81, v81, v6, v113
v_fma_f32 v82, v82, v6, v114
s_waitcnt lgkmcnt(4)
v_mfma_f32_32x32x16_bf16 v[96:111], v[56:59], a[56:59], v[96:111]
ds_read_b128 v[44:47], v30 offset:39936
v_fma_f32 v83, v83, v6, v115
v_fma_f32 v84, v84, v6, v116
s_waitcnt lgkmcnt(4)
v_mfma_f32_32x32x16_bf16 v[96:111], v[60:63], a[60:63], v[96:111]
ds_read_b128 v[48:51], v30 offset:40960
v_fma_f32 v85, v85, v6, v117
v_fma_f32 v86, v86, v6, v118
s_waitcnt lgkmcnt(4)
v_mfma_f32_32x32x16_bf16 v[96:111], v[32:35], a[64:67], v[96:111]
ds_read_b128 v[52:55], v30 offset:41984
v_fma_f32 v87, v87, v6, v119
v_exp_f32 v80, v80
s_waitcnt lgkmcnt(4)
v_mfma_f32_32x32x16_bf16 v[96:111], v[36:39], a[68:71], v[96:111]
ds_read_b128 v[56:59], v30 offset:43008
v_fma_f32 v88, v88, v4, v120
v_exp_f32 v81, v81
s_waitcnt lgkmcnt(4)
v_mfma_f32_32x32x16_bf16 v[96:111], v[40:43], a[72:75], v[96:111]
ds_read_b128 v[60:63], v30 offset:44032
v_fma_f32 v89, v89, v4, v121
v_exp_f32 v82, v82
s_waitcnt lgkmcnt(4)
v_mfma_f32_32x32x16_bf16 v[96:111], v[44:47], a[76:79], v[96:111]
ds_read_b128 v[32:35], v30 offset:45056
v_fma_f32 v90, v90, v4, v122
v_exp_f32 v83, v83
s_waitcnt vmcnt(16)
s_barrier
s_waitcnt lgkmcnt(4)
v_mfma_f32_32x32x16_bf16 v[96:111], v[48:51], a[80:83], v[96:111]
ds_read_b128 v[36:39], v30 offset:46080
v_fma_f32 v91, v91, v4, v123
v_exp_f32 v84, v84
s_waitcnt lgkmcnt(4)
v_mfma_f32_32x32x16_bf16 v[96:111], v[52:55], a[84:87], v[96:111]
ds_read_b128 v[40:43], v30 offset:47104
v_fma_f32 v92, v92, v4, v124
v_exp_f32 v85, v85
s_waitcnt lgkmcnt(4)
v_mfma_f32_32x32x16_bf16 v[96:111], v[56:59], a[88:91], v[96:111]
ds_read_b128 v[44:47], v30 offset:48128
v_fma_f32 v93, v93, v4, v125
v_exp_f32 v86, v86
s_waitcnt lgkmcnt(4)
v_mfma_f32_32x32x16_bf16 v[96:111], v[60:63], a[92:95], v[96:111]
ds_read_b128 v[48:51], v30 offset:49152
v_fma_f32 v94, v94, v4, v126
v_exp_f32 v87, v87
s_waitcnt lgkmcnt(4)
v_mfma_f32_32x32x16_bf16 v[96:111], v[32:35], a[96:99], v[96:111]
ds_read_b128 v[52:55], v30 offset:50176
v_fma_f32 v95, v95, v4, v127
v_add_f32 v80, 1.0, v80
s_waitcnt lgkmcnt(4)
v_mfma_f32_32x32x16_bf16 v[96:111], v[36:39], a[100:103], v[96:111]
ds_read_b128 v[56:59], v30 offset:51200
v_add_f32 v81, 1.0, v81
v_add_f32 v82, 1.0, v82
s_waitcnt lgkmcnt(4)
v_mfma_f32_32x32x16_bf16 v[96:111], v[40:43], a[104:107], v[96:111]
ds_read_b128 v[60:63], v30 offset:52224
v_add_f32 v83, 1.0, v83
v_add_f32 v84, 1.0, v84
s_waitcnt lgkmcnt(4)
v_mfma_f32_32x32x16_bf16 v[96:111], v[44:47], a[108:111], v[96:111]
ds_read_b128 v[32:35], v30 offset:53248
v_add_f32 v85, 1.0, v85
v_add_f32 v86, 1.0, v86
s_waitcnt lgkmcnt(4)
v_mfma_f32_32x32x16_bf16 v[96:111], v[48:51], a[112:115], v[96:111]
ds_read_b128 v[36:39], v30 offset:54272
v_add_f32 v87, 1.0, v87
v_rcp_f32 v80, v80
s_waitcnt lgkmcnt(4)
v_mfma_f32_32x32x16_bf16 v[96:111], v[52:55], a[116:119], v[96:111]
ds_read_b128 v[40:43], v30 offset:55296
v_rcp_f32 v81, v81
v_rcp_f32 v82, v82
s_waitcnt lgkmcnt(4)
v_mfma_f32_32x32x16_bf16 v[96:111], v[56:59], a[120:123], v[96:111]
ds_read_b128 v[44:47], v30 offset:56320
v_rcp_f32 v83, v83
v_rcp_f32 v84, v84
s_waitcnt lgkmcnt(4)
v_mfma_f32_32x32x16_bf16 v[96:111], v[60:63], a[124:127], v[96:111]
ds_read_b128 v[48:51], v30 offset:57344
v_rcp_f32 v85, v85
v_rcp_f32 v86, v86
s_waitcnt lgkmcnt(4)
v_mfma_f32_32x32x16_bf16 v[96:111], v[32:35], a[128:131], v[96:111]
ds_read_b128 v[52:55], v30 offset:58368
v_rcp_f32 v87, v87
v_mul_f32 v80, v80, v88
s_waitcnt lgkmcnt(4)
v_mfma_f32_32x32x16_bf16 v[96:111], v[36:39], a[132:135], v[96:111]
ds_read_b128 v[56:59], v30 offset:59392
v_mul_f32 v81, v81, v89
v_mul_f32 v82, v82, v90
s_waitcnt lgkmcnt(4)
v_mfma_f32_32x32x16_bf16 v[96:111], v[40:43], a[136:139], v[96:111]
ds_read_b128 v[60:63], v30 offset:60416
v_mul_f32 v83, v83, v91
v_mul_f32 v84, v84, v92
s_waitcnt lgkmcnt(4)
v_mfma_f32_32x32x16_bf16 v[96:111], v[44:47], a[140:143], v[96:111]
ds_read_b128 v[32:35], v1 offset:0
v_mul_f32 v85, v85, v93
v_mul_f32 v86, v86, v94
s_waitcnt lgkmcnt(4)
v_mfma_f32_32x32x16_bf16 v[96:111], v[48:51], a[144:147], v[96:111]
ds_read_b128 v[36:39], v1 offset:1024
v_mul_f32 v87, v87, v95
v_cvt_pk_bf16_f32 v18, v80, v81
v_cvt_pk_bf16_f32 v19, v82, v83
v_cvt_pk_bf16_f32 v20, v84, v85
v_cvt_pk_bf16_f32 v21, v86, v87
buffer_store_dwordx4 v[18:21], v8, s[8:11], s36 offen sc1
s_add_u32 s36, s36, 512
s_waitcnt lgkmcnt(4)
v_mfma_f32_32x32x16_bf16 v[96:111], v[52:55], a[148:151], v[96:111]
ds_read_b128 v[40:43], v1 offset:2048
s_waitcnt lgkmcnt(4)
v_mfma_f32_32x32x16_bf16 v[96:111], v[56:59], a[152:155], v[96:111]
ds_read_b128 v[44:47], v1 offset:3072
s_waitcnt lgkmcnt(4)
v_mfma_f32_32x32x16_bf16 v[96:111], v[60:63], a[156:159], v[96:111]
ds_read_b128 v[48:51], v1 offset:4096
s_waitcnt vmcnt(3)
s_barrier
s_cmp_lg_u32 s20, 0
s_cbranch_scc1 l2_kernel_sigA
s_lshl_b32 s3, s22, 2
v_mov_b32 v26, s3
v_mov_b32 v27, 1
s_mov_b64 exec, 1
v_mov_b32 v26, 0
buffer_atomic_add v27, v26, s[8:11], s81 offen sc1
s_mov_b64 exec, -1
l2_kernel_sigA:
s_cmp_eq_u32 s37, 6
s_cbranch_scc1 l2_kernel_tail6
s_waitcnt lgkmcnt(4)
s_nop 0
v_mfma_f32_32x32x16_bf16 v[64:79], v[32:35], a[0:3], 0
ds_read_b128 v[52:55], v1 offset:5120
s_waitcnt lgkmcnt(4)
v_mfma_f32_32x32x16_bf16 v[64:79], v[36:39], a[4:7], v[64:79]
ds_read_b128 v[56:59], v1 offset:6144
s_waitcnt lgkmcnt(4)
v_mfma_f32_32x32x16_bf16 v[64:79], v[40:43], a[8:11], v[64:79]
ds_read_b128 v[60:63], v1 offset:7168
ds_read_b128 v[112:115], v9 offset:640
ds_read_b128 v[116:119], v9 offset:656
s_waitcnt lgkmcnt(6)
v_mfma_f32_32x32x16_bf16 v[64:79], v[44:47], a[12:15], v[64:79]
ds_read_b128 v[32:35], v1 offset:8192
ds_read_b128 v[120:123], v9 offset:672
ds_read_b128 v[124:127], v9 offset:688
s_waitcnt lgkmcnt(8)
v_mfma_f32_32x32x16_bf16 v[64:79], v[48:51], a[16:19], v[64:79]
ds_read_b128 v[36:39], v1 offset:9216
s_waitcnt lgkmcnt(1)
v_mul_f32 v112, v7, v112
v_mfma_f32_32x32x16_bf16 v[64:79], v[52:55], a[20:23], v[64:79]
ds_read_b128 v[40:43], v1 offset:10240
v_mul_f32 v113, v7, v113
v_mul_f32 v114, v7, v114
v_mfma_f32_32x32x16_bf16 v[64:79], v[56:59], a[24:27], v[64:79]
ds_read_b128 v[44:47], v1 offset:11264
v_mul_f32 v115, v7, v115
v_mul_f32 v116, v7, v116
v_mfma_f32_32x32x16_bf16 v[64:79], v[60:63], a[28:31], v[64:79]
ds_read_b128 v[48:51], v1 offset:12288
v_mul_f32 v117, v7, v117
v_mul_f32 v118, v7, v118
v_mfma_f32_32x32x16_bf16 v[64:79], v[32:35], a[32:35], v[64:79]
ds_read_b128 v[52:55], v1 offset:13312
v_mul_f32 v119, v7, v119
v_mul_f32 v120, v5, v120
s_waitcnt lgkmcnt(4)
v_mfma_f32_32x32x16_bf16 v[64:79], v[36:39], a[36:39], v[64:79]
ds_read_b128 v[56:59], v1 offset:14336
v_mul_f32 v121, v5, v121
v_mul_f32 v122, v5, v122
s_waitcnt lgkmcnt(4)
v_mfma_f32_32x32x16_bf16 v[64:79], v[40:43], a[40:43], v[64:79]
ds_read_b128 v[60:63], v1 offset:15360
v_mul_f32 v123, v5, v123
v_mul_f32 v124, v5, v124
s_waitcnt lgkmcnt(4)
v_mfma_f32_32x32x16_bf16 v[64:79], v[44:47], a[44:47], v[64:79]
ds_read_b128 v[32:35], v1 offset:16384
v_mul_f32 v125, v5, v125
v_mul_f32 v126, v5, v126
s_waitcnt lgkmcnt(4)
v_mfma_f32_32x32x16_bf16 v[64:79], v[48:51], a[48:51], v[64:79]
ds_read_b128 v[36:39], v1 offset:17408
v_mul_f32 v127, v5, v127
v_fma_f32 v96, v96, v6, v112
s_waitcnt lgkmcnt(4)
v_mfma_f32_32x32x16_bf16 v[64:79], v[52:55], a[52:55], v[64:79]
ds_read_b128 v[40:43], v1 offset:18432
v_fma_f32 v97, v97, v6, v113
v_fma_f32 v98, v98, v6, v114
s_waitcnt lgkmcnt(4)
v_mfma_f32_32x32x16_bf16 v[64:79], v[56:59], a[56:59], v[64:79]
ds_read_b128 v[44:47], v1 offset:19456
v_fma_f32 v99, v99, v6, v115
v_fma_f32 v100, v100, v6, v116
s_waitcnt lgkmcnt(4)
v_mfma_f32_32x32x16_bf16 v[64:79], v[60:63], a[60:63], v[64:79]
ds_read_b128 v[48:51], v1 offset:40960
v_fma_f32 v101, v101, v6, v117
v_fma_f32 v102, v102, v6, v118
s_waitcnt lgkmcnt(4)
v_mfma_f32_32x32x16_bf16 v[64:79], v[32:35], a[64:67], v[64:79]
ds_read_b128 v[52:55], v1 offset:41984
v_fma_f32 v103, v103, v6, v119
v_exp_f32 v96, v96
s_waitcnt lgkmcnt(4)
v_mfma_f32_32x32x16_bf16 v[64:79], v[36:39], a[68:71], v[64:79]
ds_read_b128 v[56:59], v1 offset:43008
v_fma_f32 v104, v104, v4, v120
v_exp_f32 v97, v97
s_waitcnt lgkmcnt(4)
v_mfma_f32_32x32x16_bf16 v[64:79], v[40:43], a[72:75], v[64:79]
ds_read_b128 v[60:63], v1 offset:44032
v_fma_f32 v105, v105, v4, v121
v_exp_f32 v98, v98
v_mov_b32 v24, 0
buffer_load_dword v25, v24, s[8:11], s81 offen sc1
s_waitcnt lgkmcnt(4)
v_mfma_f32_32x32x16_bf16 v[64:79], v[44:47], a[76:79], v[64:79]
ds_read_b128 v[32:35], v1 offset:45056
v_fma_f32 v106, v106, v4, v122
v_exp_f32 v99, v99
s_waitcnt lgkmcnt(4)
v_mfma_f32_32x32x16_bf16 v[64:79], v[48:51], a[80:83], v[64:79]
ds_read_b128 v[36:39], v1 offset:46080
v_fma_f32 v107, v107, v4, v123
v_exp_f32 v100, v100
s_waitcnt lgkmcnt(4)
v_mfma_f32_32x32x16_bf16 v[64:79], v[52:55], a[84:87], v[64:79]
ds_read_b128 v[40:43], v1 offset:47104
v_fma_f32 v108, v108, v4, v124
v_exp_f32 v101, v101
s_waitcnt lgkmcnt(4)
v_mfma_f32_32x32x16_bf16 v[64:79], v[56:59], a[88:91], v[64:79]
ds_read_b128 v[44:47], v1 offset:48128
v_fma_f32 v109, v109, v4, v125
v_exp_f32 v102, v102
s_waitcnt lgkmcnt(4)
v_mfma_f32_32x32x16_bf16 v[64:79], v[60:63], a[92:95], v[64:79]
ds_read_b128 v[48:51], v1 offset:49152
v_fma_f32 v110, v110, v4, v126
v_exp_f32 v103, v103
s_waitcnt lgkmcnt(4)
v_mfma_f32_32x32x16_bf16 v[64:79], v[32:35], a[96:99], v[64:79]
ds_read_b128 v[52:55], v1 offset:50176
v_fma_f32 v111, v111, v4, v127
v_add_f32 v96, 1.0, v96
s_waitcnt lgkmcnt(4)
v_mfma_f32_32x32x16_bf16 v[64:79], v[36:39], a[100:103], v[64:79]
ds_read_b128 v[56:59], v1 offset:51200
v_add_f32 v97, 1.0, v97
v_add_f32 v98, 1.0, v98
s_waitcnt lgkmcnt(4)
v_mfma_f32_32x32x16_bf16 v[64:79], v[40:43], a[104:107], v[64:79]
ds_read_b128 v[60:63], v1 offset:52224
v_add_f32 v99, 1.0, v99
v_add_f32 v100, 1.0, v100
s_waitcnt lgkmcnt(4)
v_mfma_f32_32x32x16_bf16 v[64:79], v[44:47], a[108:111], v[64:79]
ds_read_b128 v[32:35], v1 offset:53248
v_add_f32 v101, 1.0, v101
v_add_f32 v102, 1.0, v102
s_waitcnt lgkmcnt(4)
v_mfma_f32_32x32x16_bf16 v[64:79], v[48:51], a[112:115], v[64:79]
ds_read_b128 v[36:39], v1 offset:54272
v_add_f32 v103, 1.0, v103
v_rcp_f32 v96, v96
s_waitcnt lgkmcnt(4)
v_mfma_f32_32x32x16_bf16 v[64:79], v[52:55], a[116:119], v[64:79]
ds_read_b128 v[40:43], v1 offset:55296
v_rcp_f32 v97, v97
v_rcp_f32 v98, v98
s_waitcnt lgkmcnt(4)
v_mfma_f32_32x32x16_bf16 v[64:79], v[56:59], a[120:123], v[64:79]
ds_read_b128 v[44:47], v1 offset:56320
v_rcp_f32 v99, v99
v_rcp_f32 v100, v100
s_waitcnt vmcnt(0)
v_cmp_gt_u32 vcc, 16, v25
s_nop 4
s_cmp_eq_u64 vcc, 0
s_cselect_b32 s73, 1, 0
s_waitcnt lgkmcnt(4)
v_mfma_f32_32x32x16_bf16 v[64:79], v[60:63], a[124:127], v[64:79]
ds_read_b128 v[48:51], v1 offset:57344
v_rcp_f32 v101, v101
v_rcp_f32 v102, v102
s_waitcnt lgkmcnt(4)
v_mfma_f32_32x32x16_bf16 v[64:79], v[32:35], a[128:131], v[64:79]
ds_read_b128 v[52:55], v1 offset:58368
v_rcp_f32 v103, v103
v_mul_f32 v96, v96, v104
s_cmp_eq_u32 s73, 1
s_cbranch_scc0 l2_kernel_hskip0
v_lshl_add_u32 v28, s40, 10, v1
buffer_load_dwordx4 a[0:3], v28, s[8:11], s56 offen sc1
buffer_load_dwordx4 a[4:7], v28, s[8:11], s57 offen sc1
buffer_load_dwordx4 a[8:11], v28, s[8:11], s58 offen sc1
buffer_load_dwordx4 a[12:15], v28, s[8:11], s59 offen sc1
l2_kernel_hskip0:
s_waitcnt lgkmcnt(4)
v_mfma_f32_32x32x16_bf16 v[64:79], v[36:39], a[132:135], v[64:79]
ds_read_b128 v[56:59], v1 offset:59392
v_mul_f32 v97, v97, v105
v_mul_f32 v98, v98, v106
s_waitcnt lgkmcnt(4)
v_mfma_f32_32x32x16_bf16 v[64:79], v[40:43], a[136:139], v[64:79]
ds_read_b128 v[60:63], v1 offset:60416
v_mul_f32 v99, v99, v107
v_mul_f32 v100, v100, v108
s_cmp_eq_u32 s73, 1
s_cbranch_scc0 l2_kernel_hskip1
v_lshl_add_u32 v28, s41, 10, v1
buffer_load_dwordx4 a[16:19], v28, s[8:11], s56 offen sc1
buffer_load_dwordx4 a[20:23], v28, s[8:11], s57 offen sc1
buffer_load_dwordx4 a[24:27], v28, s[8:11], s58 offen sc1
buffer_load_dwordx4 a[28:31], v28, s[8:11], s59 offen sc1
l2_kernel_hskip1:
s_waitcnt lgkmcnt(4)
v_mfma_f32_32x32x16_bf16 v[64:79], v[44:47], a[140:143], v[64:79]
v_mul_f32 v101, v101, v109
v_mul_f32 v102, v102, v110
s_waitcnt lgkmcnt(3)
v_mfma_f32_32x32x16_bf16 v[64:79], v[48:51], a[144:147], v[64:79]
v_mul_f32 v103, v103, v111
v_cvt_pk_bf16_f32 v18, v96, v97
v_cvt_pk_bf16_f32 v19, v98, v99
v_cvt_pk_bf16_f32 v20, v100, v101
v_cvt_pk_bf16_f32 v21, v102, v103
buffer_store_dwordx4 v[18:21], v8, s[8:11], s36 offen sc1
s_add_u32 s36, s36, 512
s_cmp_eq_u32 s73, 1
s_cbranch_scc0 l2_kernel_hskip2
v_lshl_add_u32 v28, s42, 10, v1
buffer_load_dwordx4 a[32:35], v28, s[8:11], s56 offen sc1
buffer_load_dwordx4 a[36:39], v28, s[8:11], s57 offen sc1
buffer_load_dwordx4 a[40:43], v28, s[8:11], s58 offen sc1
buffer_load_dwordx4 a[44:47], v28, s[8:11], s59 offen sc1
l2_kernel_hskip2:
s_waitcnt lgkmcnt(2)
v_mfma_f32_32x32x16_bf16 v[64:79], v[52:55], a[148:151], v[64:79]
s_waitcnt lgkmcnt(1)
v_mfma_f32_32x32x16_bf16 v[64:79], v[56:59], a[152:155], v[64:79]
s_waitcnt lgkmcnt(0)
v_mfma_f32_32x32x16_bf16 v[64:79], v[60:63], a[156:159], v[64:79]
ds_read_b128 v[112:115], v9 offset:768
ds_read_b128 v[116:119], v9 offset:784
ds_read_b128 v[120:123], v9 offset:800
ds_read_b128 v[124:127], v9 offset:816
s_waitcnt lgkmcnt(0)
v_mul_f32 v112, v7, v112
v_mul_f32 v113, v7, v113
v_mul_f32 v114, v7, v114
v_mul_f32 v115, v7, v115
v_mul_f32 v116, v7, v116
v_mul_f32 v117, v7, v117
v_mul_f32 v118, v7, v118
v_mul_f32 v119, v7, v119
v_mul_f32 v120, v5, v120
v_mul_f32 v121, v5, v121
v_mul_f32 v122, v5, v122
v_mul_f32 v123, v5, v123
v_mul_f32 v124, v5, v124
v_mul_f32 v125, v5, v125
v_mul_f32 v126, v5, v126
v_mul_f32 v127, v5, v127
v_fma_f32 v64, v64, v6, v112
v_fma_f32 v65, v65, v6, v113
v_fma_f32 v66, v66, v6, v114
v_fma_f32 v67, v67, v6, v115
v_fma_f32 v68, v68, v6, v116
v_fma_f32 v69, v69, v6, v117
v_fma_f32 v70, v70, v6, v118
v_fma_f32 v71, v71, v6, v119
v_exp_f32 v64, v64
v_fma_f32 v72, v72, v4, v120
v_exp_f32 v65, v65
v_fma_f32 v73, v73, v4, v121
v_exp_f32 v66, v66
v_fma_f32 v74, v74, v4, v122
v_exp_f32 v67, v67
v_fma_f32 v75, v75, v4, v123
v_exp_f32 v68, v68
v_fma_f32 v76, v76, v4, v124
v_exp_f32 v69, v69
v_fma_f32 v77, v77, v4, v125
v_exp_f32 v70, v70
v_fma_f32 v78, v78, v4, v126
v_exp_f32 v71, v71
v_fma_f32 v79, v79, v4, v127
v_add_f32 v64, 1.0, v64
v_add_f32 v65, 1.0, v65
v_add_f32 v66, 1.0, v66
v_add_f32 v67, 1.0, v67
v_add_f32 v68, 1.0, v68
v_add_f32 v69, 1.0, v69
v_add_f32 v70, 1.0, v70
v_add_f32 v71, 1.0, v71
v_rcp_f32 v64, v64
v_rcp_f32 v65, v65
v_rcp_f32 v66, v66
v_rcp_f32 v67, v67
v_rcp_f32 v68, v68
v_rcp_f32 v69, v69
v_rcp_f32 v70, v70
v_rcp_f32 v71, v71
v_mul_f32 v64, v64, v72
v_mul_f32 v65, v65, v73
v_mul_f32 v66, v66, v74
v_mul_f32 v67, v67, v75
v_mul_f32 v68, v68, v76
v_mul_f32 v69, v69, v77
v_mul_f32 v70, v70, v78
v_mul_f32 v71, v71, v79
v_cvt_pk_bf16_f32 v18, v64, v65
v_cvt_pk_bf16_f32 v19, v66, v67
v_cvt_pk_bf16_f32 v20, v68, v69
v_cvt_pk_bf16_f32 v21, v70, v71
buffer_store_dwordx4 v[18:21], v8, s[8:11], s36 offen sc1
s_cmp_eq_u32 s73, 1
s_cbranch_scc1 l2_kernel_t7_rdy
s_mov_b32 s7, 0
l2_kernel_t7_pa_retry:
v_mov_b32 v24, 0
buffer_load_dword v25, v24, s[8:11], s81 offen sc1
s_waitcnt vmcnt(0)
v_cmp_gt_u32 vcc, 16, v25
s_nop 4
s_cbranch_vccz l2_kernel_t7_pa_ok
s_add_u32 s7, s7, 1
s_cmp_lt_u32 s7, 400000
s_cbranch_scc0 l2_kernel_t7_pa_ok
s_branch l2_kernel_t7_pa_retry
l2_kernel_t7_pa_ok:
v_lshl_add_u32 v28, s40, 10, v1
buffer_load_dwordx4 a[0:3], v28, s[8:11], s56 offen sc1
buffer_load_dwordx4 a[4:7], v28, s[8:11], s57 offen sc1
buffer_load_dwordx4 a[8:11], v28, s[8:11], s58 offen sc1
buffer_load_dwordx4 a[12:15], v28, s[8:11], s59 offen sc1
v_lshl_add_u32 v28, s41, 10, v1
buffer_load_dwordx4 a[16:19], v28, s[8:11], s56 offen sc1
buffer_load_dwordx4 a[20:23], v28, s[8:11], s57 offen sc1
buffer_load_dwordx4 a[24:27], v28, s[8:11], s58 offen sc1
buffer_load_dwordx4 a[28:31], v28, s[8:11], s59 offen sc1
v_lshl_add_u32 v28, s42, 10, v1
buffer_load_dwordx4 a[32:35], v28, s[8:11], s56 offen sc1
buffer_load_dwordx4 a[36:39], v28, s[8:11], s57 offen sc1
buffer_load_dwordx4 a[40:43], v28, s[8:11], s58 offen sc1
buffer_load_dwordx4 a[44:47], v28, s[8:11], s59 offen sc1
l2_kernel_t7_rdy:
s_add_u32 s36, s36, 512
s_branch l2_kernel_g1end
l2_kernel_tail6:
ds_read_b128 v[112:115], v9 offset:640
ds_read_b128 v[116:119], v9 offset:656
ds_read_b128 v[120:123], v9 offset:672
ds_read_b128 v[124:127], v9 offset:688
s_waitcnt lgkmcnt(0)
v_mul_f32 v112, v7, v112
v_mul_f32 v113, v7, v113
v_mul_f32 v114, v7, v114
v_mul_f32 v115, v7, v115
v_mul_f32 v116, v7, v116
v_mul_f32 v117, v7, v117
v_mul_f32 v118, v7, v118
v_mul_f32 v119, v7, v119
v_mul_f32 v120, v5, v120
v_mul_f32 v121, v5, v121
v_mul_f32 v122, v5, v122
v_mul_f32 v123, v5, v123
v_mul_f32 v124, v5, v124
v_mul_f32 v125, v5, v125
v_mul_f32 v126, v5, v126
v_mul_f32 v127, v5, v127
v_fma_f32 v96, v96, v6, v112
v_fma_f32 v97, v97, v6, v113
v_fma_f32 v98, v98, v6, v114
v_fma_f32 v99, v99, v6, v115
v_fma_f32 v100, v100, v6, v116
v_fma_f32 v101, v101, v6, v117
v_fma_f32 v102, v102, v6, v118
v_fma_f32 v103, v103, v6, v119
v_exp_f32 v96, v96
v_fma_f32 v104, v104, v4, v120
v_exp_f32 v97, v97
v_fma_f32 v105, v105, v4, v121
v_exp_f32 v98, v98
v_fma_f32 v106, v106, v4, v122
v_exp_f32 v99, v99
v_fma_f32 v107, v107, v4, v123
v_exp_f32 v100, v100
v_fma_f32 v108, v108, v4, v124
v_exp_f32 v101, v101
v_fma_f32 v109, v109, v4, v125
v_exp_f32 v102, v102
v_fma_f32 v110, v110, v4, v126
v_exp_f32 v103, v103
v_fma_f32 v111, v111, v4, v127
v_add_f32 v96, 1.0, v96
v_add_f32 v97, 1.0, v97
v_add_f32 v98, 1.0, v98
v_add_f32 v99, 1.0, v99
v_add_f32 v100, 1.0, v100
v_add_f32 v101, 1.0, v101
v_add_f32 v102, 1.0, v102
v_add_f32 v103, 1.0, v103
v_rcp_f32 v96, v96
v_rcp_f32 v97, v97
v_rcp_f32 v98, v98
v_rcp_f32 v99, v99
v_rcp_f32 v100, v100
v_rcp_f32 v101, v101
v_rcp_f32 v102, v102
v_rcp_f32 v103, v103
v_mul_f32 v96, v96, v104
v_mul_f32 v97, v97, v105
v_mul_f32 v98, v98, v106
v_mul_f32 v99, v99, v107
v_mul_f32 v100, v100, v108
v_mul_f32 v101, v101, v109
v_mul_f32 v102, v102, v110
v_mul_f32 v103, v103, v111
v_cvt_pk_bf16_f32 v18, v96, v97
v_cvt_pk_bf16_f32 v19, v98, v99
v_cvt_pk_bf16_f32 v20, v100, v101
v_cvt_pk_bf16_f32 v21, v102, v103
v_mov_b32 v24, 0
buffer_load_dword v25, v24, s[8:11], s81 offen sc1
buffer_store_dwordx4 v[18:21], v8, s[8:11], s36 offen sc1
s_waitcnt vmcnt(1)
v_cmp_gt_u32 vcc, 16, v25
s_nop 4
s_cbranch_vccz l2_kernel_t6_aok
s_mov_b32 s7, 0
l2_kernel_t6_pa_retry:
v_mov_b32 v24, 0
buffer_load_dword v25, v24, s[8:11], s81 offen sc1
s_waitcnt vmcnt(0)
v_cmp_gt_u32 vcc, 16, v25
s_nop 4
s_cbranch_vccz l2_kernel_t6_pa_ok
s_add_u32 s7, s7, 1
s_cmp_lt_u32 s7, 400000
s_cbranch_scc0 l2_kernel_t6_pa_ok
s_branch l2_kernel_t6_pa_retry
l2_kernel_t6_pa_ok:
l2_kernel_t6_aok:
v_lshl_add_u32 v28, s40, 10, v1
buffer_load_dwordx4 a[0:3], v28, s[8:11], s56 offen sc1
buffer_load_dwordx4 a[4:7], v28, s[8:11], s57 offen sc1
buffer_load_dwordx4 a[8:11], v28, s[8:11], s58 offen sc1
buffer_load_dwordx4 a[12:15], v28, s[8:11], s59 offen sc1
v_lshl_add_u32 v28, s41, 10, v1
buffer_load_dwordx4 a[16:19], v28, s[8:11], s56 offen sc1
buffer_load_dwordx4 a[20:23], v28, s[8:11], s57 offen sc1
buffer_load_dwordx4 a[24:27], v28, s[8:11], s58 offen sc1
buffer_load_dwordx4 a[28:31], v28, s[8:11], s59 offen sc1
v_lshl_add_u32 v28, s42, 10, v1
buffer_load_dwordx4 a[32:35], v28, s[8:11], s56 offen sc1
buffer_load_dwordx4 a[36:39], v28, s[8:11], s57 offen sc1
buffer_load_dwordx4 a[40:43], v28, s[8:11], s58 offen sc1
buffer_load_dwordx4 a[44:47], v28, s[8:11], s59 offen sc1
s_add_u32 s36, s36, 512
l2_kernel_g1end:
v_and_b32 v2, 15, v0
v_bfe_u32 v3, v0, 4, 2
s_and_b32 s3, s20, 1
s_lshl_b32 s3, s3, 4
v_add_u32 v13, s3, v2
v_lshlrev_b32 v14, 9, v3
v_lshl_add_u32 v14, v13, 4, v14
v_lshrrev_b32 v15, 1, v3
v_lshlrev_b32 v15, 9, v15
v_lshl_add_u32 v15, v13, 4, v15
v_and_b32 v16, 1, v3
v_lshl_add_u32 v15, v16, 3, v15
s_waitcnt vmcnt(8)
v_mfma_f32_16x16x32_bf16 a[64:67], a[160:163], a[0:3], 0
v_mfma_f32_16x16x32_bf16 a[84:87], a[160:163], a[4:7], 0
v_lshl_add_u32 v5, s43, 10, v1
buffer_load_dwordx4 a[48:51], v5, s[8:11], s56 offen sc1
v_mfma_f32_16x16x32_bf16 a[104:107], a[160:163], a[8:11], 0
v_mfma_f32_16x16x32_bf16 a[124:127], a[160:163], a[12:15], 0
v_mfma_f32_16x16x32_bf16 a[68:71], a[164:167], a[0:3], 0
v_mfma_f32_16x16x32_bf16 a[88:91], a[164:167], a[4:7], 0
buffer_load_dwordx4 a[52:55], v5, s[8:11], s57 offen sc1
v_mfma_f32_16x16x32_bf16 a[108:111], a[164:167], a[8:11], 0
v_mfma_f32_16x16x32_bf16 a[128:131], a[164:167], a[12:15], 0
s_mul_i32 s5, s51, 5120
v_add_u32 v6, s5, v1
buffer_load_dwordx4 v[32:35], v6, s[8:11], s54 offen offset:1024
v_mfma_f32_16x16x32_bf16 a[72:75], a[168:171], a[0:3], 0
v_mfma_f32_16x16x32_bf16 a[92:95], a[168:171], a[4:7], 0
buffer_load_dwordx4 a[56:59], v5, s[8:11], s58 offen sc1
v_mfma_f32_16x16x32_bf16 a[112:115], a[168:171], a[8:11], 0
v_mfma_f32_16x16x32_bf16 a[132:135], a[168:171], a[12:15], 0
buffer_load_dwordx4 v[36:39], v6, s[8:11], s54 offen offset:2048
v_mfma_f32_16x16x32_bf16 a[76:79], a[172:175], a[0:3], 0
v_mfma_f32_16x16x32_bf16 a[96:99], a[172:175], a[4:7], 0
buffer_load_dwordx4 a[60:63], v5, s[8:11], s59 offen sc1
v_mfma_f32_16x16x32_bf16 a[116:119], a[172:175], a[8:11], 0
v_mfma_f32_16x16x32_bf16 a[136:139], a[172:175], a[12:15], 0
buffer_load_dwordx4 v[40:43], v6, s[8:11], s54 offen offset:3072
v_mfma_f32_16x16x32_bf16 a[80:83], a[176:179], a[0:3], 0
v_mfma_f32_16x16x32_bf16 a[100:103], a[176:179], a[4:7], 0
v_mfma_f32_16x16x32_bf16 a[120:123], a[176:179], a[8:11], 0
v_mfma_f32_16x16x32_bf16 a[140:143], a[176:179], a[12:15], 0
s_waitcnt vmcnt(8)
s_barrier
s_add_u32 s79, s81, 128
s_cmp_lg_u32 s20, 0
s_cbranch_scc1 l2_kernel_sigA2
s_lshl_b32 s3, s22, 2
v_mov_b32 v24, s3
v_mov_b32 v25, 1
s_mov_b64 exec, 1
v_mov_b32 v24, 0
buffer_atomic_add v25, v24, s[8:11], s79 offen sc1
s_mov_b64 exec, -1
l2_kernel_sigA2:
s_waitcnt vmcnt(11)
s_nop 2
v_mfma_f32_16x16x32_bf16 a[64:67], a[180:183], a[16:19], a[64:67]
v_mfma_f32_16x16x32_bf16 a[84:87], a[180:183], a[20:23], a[84:87]
v_lshl_add_u32 v4, s44, 10, v1
buffer_load_dwordx4 a[0:3], v4, s[8:11], s56 offen sc1
v_mfma_f32_16x16x32_bf16 a[104:107], a[180:183], a[24:27], a[104:107]
v_mfma_f32_16x16x32_bf16 a[124:127], a[180:183], a[28:31], a[124:127]
v_mfma_f32_16x16x32_bf16 a[68:71], a[184:187], a[16:19], a[68:71]
v_mfma_f32_16x16x32_bf16 a[88:91], a[184:187], a[20:23], a[88:91]
buffer_load_dwordx4 a[4:7], v4, s[8:11], s57 offen sc1
v_mfma_f32_16x16x32_bf16 a[108:111], a[184:187], a[24:27], a[108:111]
v_mfma_f32_16x16x32_bf16 a[128:131], a[184:187], a[28:31], a[128:131]
buffer_load_dwordx4 v[44:47], v6, s[8:11], s55 offen
v_mfma_f32_16x16x32_bf16 a[72:75], a[188:191], a[16:19], a[72:75]
v_mfma_f32_16x16x32_bf16 a[92:95], a[188:191], a[20:23], a[92:95]
buffer_load_dwordx4 a[8:11], v4, s[8:11], s58 offen sc1
v_mfma_f32_16x16x32_bf16 a[112:115], a[188:191], a[24:27], a[112:115]
v_mfma_f32_16x16x32_bf16 a[132:135], a[188:191], a[28:31], a[132:135]
s_mul_i32 s5, s52, 5120
v_add_u32 v6, s5, v1
buffer_load_dwordx4 v[48:51], v6, s[8:11], s54 offen offset:0
v_mfma_f32_16x16x32_bf16 a[76:79], a[192:195], a[16:19], a[76:79]
v_mfma_f32_16x16x32_bf16 a[96:99], a[192:195], a[20:23], a[96:99]
buffer_load_dwordx4 a[12:15], v4, s[8:11], s59 offen sc1
v_mfma_f32_16x16x32_bf16 a[116:119], a[192:195], a[24:27], a[116:119]
v_mfma_f32_16x16x32_bf16 a[136:139], a[192:195], a[28:31], a[136:139]
buffer_load_dwordx4 v[52:55], v6, s[8:11], s54 offen offset:1024
v_mfma_f32_16x16x32_bf16 a[80:83], a[196:199], a[16:19], a[80:83]
v_mfma_f32_16x16x32_bf16 a[100:103], a[196:199], a[20:23], a[100:103]
v_mfma_f32_16x16x32_bf16 a[120:123], a[196:199], a[24:27], a[120:123]
v_mfma_f32_16x16x32_bf16 a[140:143], a[196:199], a[28:31], a[140:143]
s_waitcnt vmcnt(14)
v_mfma_f32_16x16x32_bf16 a[64:67], a[200:203], a[32:35], a[64:67]
v_mfma_f32_16x16x32_bf16 a[84:87], a[200:203], a[36:39], a[84:87]
v_lshl_add_u32 v5, s45, 10, v1
buffer_load_dwordx4 a[16:19], v5, s[8:11], s56 offen sc1
v_mfma_f32_16x16x32_bf16 a[104:107], a[200:203], a[40:43], a[104:107]
v_mfma_f32_16x16x32_bf16 a[124:127], a[200:203], a[44:47], a[124:127]
v_mfma_f32_16x16x32_bf16 a[68:71], a[204:207], a[32:35], a[68:71]
v_mfma_f32_16x16x32_bf16 a[88:91], a[204:207], a[36:39], a[88:91]
buffer_load_dwordx4 a[20:23], v5, s[8:11], s57 offen sc1
v_mfma_f32_16x16x32_bf16 a[108:111], a[204:207], a[40:43], a[108:111]
v_mfma_f32_16x16x32_bf16 a[128:131], a[204:207], a[44:47], a[128:131]
buffer_load_dwordx4 v[56:59], v6, s[8:11], s54 offen offset:2048
v_mfma_f32_16x16x32_bf16 a[72:75], a[208:211], a[32:35], a[72:75]
v_mfma_f32_16x16x32_bf16 a[92:95], a[208:211], a[36:39], a[92:95]
buffer_load_dwordx4 a[24:27], v5, s[8:11], s58 offen sc1
v_mfma_f32_16x16x32_bf16 a[112:115], a[208:211], a[40:43], a[112:115]
v_mfma_f32_16x16x32_bf16 a[132:135], a[208:211], a[44:47], a[132:135]
buffer_load_dwordx4 v[60:63], v6, s[8:11], s54 offen offset:3072
v_mfma_f32_16x16x32_bf16 a[76:79], a[212:215], a[32:35], a[76:79]
v_mfma_f32_16x16x32_bf16 a[96:99], a[212:215], a[36:39], a[96:99]
buffer_load_dwordx4 a[28:31], v5, s[8:11], s59 offen sc1
v_mfma_f32_16x16x32_bf16 a[116:119], a[212:215], a[40:43], a[116:119]
v_mfma_f32_16x16x32_bf16 a[136:139], a[212:215], a[44:47], a[136:139]
buffer_load_dwordx4 v[64:67], v6, s[8:11], s55 offen
v_mfma_f32_16x16x32_bf16 a[80:83], a[216:219], a[32:35], a[80:83]
v_mfma_f32_16x16x32_bf16 a[100:103], a[216:219], a[36:39], a[100:103]
v_mfma_f32_16x16x32_bf16 a[120:123], a[216:219], a[40:43], a[120:123]
v_mfma_f32_16x16x32_bf16 a[140:143], a[216:219], a[44:47], a[140:143]
s_add_u32 s79, s81, 128
v_mov_b32 v27, 0
buffer_load_dword v28, v27, s[8:11], s79 offen sc1
s_waitcnt vmcnt(16)
v_mfma_f32_16x16x32_bf16 a[64:67], a[220:223], a[48:51], a[64:67]
v_mfma_f32_16x16x32_bf16 a[84:87], a[220:223], a[52:55], a[84:87]
v_mfma_f32_16x16x32_bf16 a[104:107], a[220:223], a[56:59], a[104:107]
v_mfma_f32_16x16x32_bf16 a[124:127], a[220:223], a[60:63], a[124:127]
v_mfma_f32_16x16x32_bf16 a[68:71], a[224:227], a[48:51], a[68:71]
v_mfma_f32_16x16x32_bf16 a[88:91], a[224:227], a[52:55], a[88:91]
v_mfma_f32_16x16x32_bf16 a[108:111], a[224:227], a[56:59], a[108:111]
v_mfma_f32_16x16x32_bf16 a[128:131], a[224:227], a[60:63], a[128:131]
s_mul_i32 s5, s53, 5120
v_add_u32 v6, s5, v1
buffer_load_dwordx4 v[68:71], v6, s[8:11], s54 offen offset:0
v_mfma_f32_16x16x32_bf16 a[72:75], a[228:231], a[48:51], a[72:75]
v_mfma_f32_16x16x32_bf16 a[92:95], a[228:231], a[52:55], a[92:95]
v_mfma_f32_16x16x32_bf16 a[112:115], a[228:231], a[56:59], a[112:115]
v_mfma_f32_16x16x32_bf16 a[132:135], a[228:231], a[60:63], a[132:135]
buffer_load_dwordx4 v[72:75], v6, s[8:11], s54 offen offset:1024
v_mfma_f32_16x16x32_bf16 a[76:79], a[232:235], a[48:51], a[76:79]
v_mfma_f32_16x16x32_bf16 a[96:99], a[232:235], a[52:55], a[96:99]
v_mfma_f32_16x16x32_bf16 a[116:119], a[232:235], a[56:59], a[116:119]
v_mfma_f32_16x16x32_bf16 a[136:139], a[232:235], a[60:63], a[136:139]
buffer_load_dwordx4 v[76:79], v6, s[8:11], s54 offen offset:2048
v_mfma_f32_16x16x32_bf16 a[80:83], a[236:239], a[48:51], a[80:83]
v_mfma_f32_16x16x32_bf16 a[100:103], a[236:239], a[52:55], a[100:103]
v_mfma_f32_16x16x32_bf16 a[120:123], a[236:239], a[56:59], a[120:123]
v_mfma_f32_16x16x32_bf16 a[140:143], a[236:239], a[60:63], a[140:143]
s_waitcnt vmcnt(25)
s_barrier
s_cmp_lg_u32 s20, 0
s_cbranch_scc1 l2_kernel_sigB
s_lshl_b32 s3, s22, 2
v_mov_b32 v24, s3
v_mov_b32 v25, 1
s_mov_b64 exec, 1
v_mov_b32 v24, 0
buffer_atomic_add v25, v24, s[8:11], s82 offen sc1
s_mov_b64 exec, -1
l2_kernel_sigB:
s_waitcnt vmcnt(12)
s_nop 2
v_mfma_f32_16x16x32_bf16 a[64:67], a[240:243], a[0:3], a[64:67]
v_mfma_f32_16x16x32_bf16 a[84:87], a[240:243], a[4:7], a[84:87]
v_mfma_f32_16x16x32_bf16 a[104:107], a[240:243], a[8:11], a[104:107]
v_mfma_f32_16x16x32_bf16 a[124:127], a[240:243], a[12:15], a[124:127]
v_mfma_f32_16x16x32_bf16 a[68:71], a[244:247], a[0:3], a[68:71]
v_mfma_f32_16x16x32_bf16 a[88:91], a[244:247], a[4:7], a[88:91]
v_mfma_f32_16x16x32_bf16 a[108:111], a[244:247], a[8:11], a[108:111]
v_mfma_f32_16x16x32_bf16 a[128:131], a[244:247], a[12:15], a[128:131]
buffer_load_dwordx4 v[80:83], v6, s[8:11], s54 offen offset:3072
v_mfma_f32_16x16x32_bf16 a[72:75], a[248:251], a[0:3], a[72:75]
v_mfma_f32_16x16x32_bf16 a[92:95], a[248:251], a[4:7], a[92:95]
v_mfma_f32_16x16x32_bf16 a[112:115], a[248:251], a[8:11], a[112:115]
v_mfma_f32_16x16x32_bf16 a[132:135], a[248:251], a[12:15], a[132:135]
buffer_load_dwordx4 v[84:87], v6, s[8:11], s55 offen
v_mfma_f32_16x16x32_bf16 a[76:79], a[252:255], a[0:3], a[76:79]
v_mfma_f32_16x16x32_bf16 a[96:99], a[252:255], a[4:7], a[96:99]
v_mfma_f32_16x16x32_bf16 a[116:119], a[252:255], a[8:11], a[116:119]
v_mfma_f32_16x16x32_bf16 a[136:139], a[252:255], a[12:15], a[136:139]
v_mfma_f32_16x16x32_bf16 a[80:83], v[128:131], a[0:3], a[80:83]
v_mfma_f32_16x16x32_bf16 a[100:103], v[128:131], a[4:7], a[100:103]
v_mfma_f32_16x16x32_bf16 a[120:123], v[128:131], a[8:11], a[120:123]
v_mfma_f32_16x16x32_bf16 a[140:143], v[128:131], a[12:15], a[140:143]
s_waitcnt vmcnt(5)
v_cmp_gt_u32 vcc, 16, v28
s_nop 4
s_cbranch_vccz l2_kernel_pm_fast
s_mov_b32 s7, 0
l2_kernel_pm_retry:
v_mov_b32 v24, 0
buffer_load_dword v25, v24, s[8:11], s79 offen sc1
s_waitcnt vmcnt(0)
v_cmp_gt_u32 vcc, 16, v25
s_nop 4
s_cbranch_vccz l2_kernel_pm_ok
s_add_u32 s7, s7, 1
s_cmp_lt_u32 s7, 400000
s_cbranch_scc0 l2_kernel_pm_ok
s_branch l2_kernel_pm_retry
l2_kernel_pm_ok:
l2_kernel_pm_fast:
v_lshl_add_u32 v4, s46, 10, v1
buffer_load_dwordx4 a[32:35], v4, s[8:11], s56 offen sc1
buffer_load_dwordx4 a[36:39], v4, s[8:11], s57 offen sc1
buffer_load_dwordx4 a[40:43], v4, s[8:11], s58 offen sc1
buffer_load_dwordx4 a[44:47], v4, s[8:11], s59 offen sc1
v_mfma_f32_16x16x32_bf16 a[64:67], v[132:135], a[16:19], a[64:67]
v_mfma_f32_16x16x32_bf16 a[84:87], v[132:135], a[20:23], a[84:87]
v_lshl_add_u32 v5, s47, 10, v1
buffer_load_dwordx4 a[48:51], v5, s[8:11], s56 offen sc1
v_mfma_f32_16x16x32_bf16 a[104:107], v[132:135], a[24:27], a[104:107]
v_mfma_f32_16x16x32_bf16 a[124:127], v[132:135], a[28:31], a[124:127]
v_mfma_f32_16x16x32_bf16 a[68:71], v[136:139], a[16:19], a[68:71]
v_mfma_f32_16x16x32_bf16 a[88:91], v[136:139], a[20:23], a[88:91]
buffer_load_dwordx4 a[52:55], v5, s[8:11], s57 offen sc1
v_mfma_f32_16x16x32_bf16 a[108:111], v[136:139], a[24:27], a[108:111]
v_mfma_f32_16x16x32_bf16 a[128:131], v[136:139], a[28:31], a[128:131]
v_mfma_f32_16x16x32_bf16 a[72:75], v[140:143], a[16:19], a[72:75]
v_mfma_f32_16x16x32_bf16 a[92:95], v[140:143], a[20:23], a[92:95]
buffer_load_dwordx4 a[56:59], v5, s[8:11], s58 offen sc1
v_mfma_f32_16x16x32_bf16 a[112:115], v[140:143], a[24:27], a[112:115]
v_mfma_f32_16x16x32_bf16 a[132:135], v[140:143], a[28:31], a[132:135]
v_mfma_f32_16x16x32_bf16 a[76:79], v[144:147], a[16:19], a[76:79]
v_mfma_f32_16x16x32_bf16 a[96:99], v[144:147], a[20:23], a[96:99]
buffer_load_dwordx4 a[60:63], v5, s[8:11], s59 offen sc1
v_mfma_f32_16x16x32_bf16 a[116:119], v[144:147], a[24:27], a[116:119]
v_mfma_f32_16x16x32_bf16 a[136:139], v[144:147], a[28:31], a[136:139]
v_mfma_f32_16x16x32_bf16 a[80:83], v[148:151], a[16:19], a[80:83]
v_mfma_f32_16x16x32_bf16 a[100:103], v[148:151], a[20:23], a[100:103]
v_lshl_add_u32 v4, s48, 10, v1
buffer_load_dwordx4 a[0:3], v4, s[8:11], s56 offen sc1
v_mfma_f32_16x16x32_bf16 a[120:123], v[148:151], a[24:27], a[120:123]
v_mfma_f32_16x16x32_bf16 a[140:143], v[148:151], a[28:31], a[140:143]
v_mov_b32 v27, 0
buffer_load_dword v28, v27, s[8:11], s82 offen sc1
s_waitcnt vmcnt(6)
v_mfma_f32_16x16x32_bf16 a[64:67], v[152:155], a[32:35], a[64:67]
v_mfma_f32_16x16x32_bf16 a[84:87], v[152:155], a[36:39], a[84:87]
buffer_load_dwordx4 a[4:7], v4, s[8:11], s57 offen sc1
v_mfma_f32_16x16x32_bf16 a[104:107], v[152:155], a[40:43], a[104:107]
v_mfma_f32_16x16x32_bf16 a[124:127], v[152:155], a[44:47], a[124:127]
v_mfma_f32_16x16x32_bf16 a[68:71], v[156:159], a[32:35], a[68:71]
v_mfma_f32_16x16x32_bf16 a[88:91], v[156:159], a[36:39], a[88:91]
buffer_load_dwordx4 a[8:11], v4, s[8:11], s58 offen sc1
v_mfma_f32_16x16x32_bf16 a[108:111], v[156:159], a[40:43], a[108:111]
v_mfma_f32_16x16x32_bf16 a[128:131], v[156:159], a[44:47], a[128:131]
v_mfma_f32_16x16x32_bf16 a[72:75], v[160:163], a[32:35], a[72:75]
v_mfma_f32_16x16x32_bf16 a[92:95], v[160:163], a[36:39], a[92:95]
buffer_load_dwordx4 a[12:15], v4, s[8:11], s59 offen sc1
v_mfma_f32_16x16x32_bf16 a[112:115], v[160:163], a[40:43], a[112:115]
v_mfma_f32_16x16x32_bf16 a[132:135], v[160:163], a[44:47], a[132:135]
v_mfma_f32_16x16x32_bf16 a[76:79], v[164:167], a[32:35], a[76:79]
v_mfma_f32_16x16x32_bf16 a[96:99], v[164:167], a[36:39], a[96:99]
v_mfma_f32_16x16x32_bf16 a[116:119], v[164:167], a[40:43], a[116:119]
v_mfma_f32_16x16x32_bf16 a[136:139], v[164:167], a[44:47], a[136:139]
v_mfma_f32_16x16x32_bf16 a[80:83], v[168:171], a[32:35], a[80:83]
v_mfma_f32_16x16x32_bf16 a[100:103], v[168:171], a[36:39], a[100:103]
v_mfma_f32_16x16x32_bf16 a[120:123], v[168:171], a[40:43], a[120:123]
v_mfma_f32_16x16x32_bf16 a[140:143], v[168:171], a[44:47], a[140:143]
s_waitcnt vmcnt(5)
v_mfma_f32_16x16x32_bf16 a[64:67], v[172:175], a[48:51], a[64:67]
v_mfma_f32_16x16x32_bf16 a[84:87], v[172:175], a[52:55], a[84:87]
v_mfma_f32_16x16x32_bf16 a[104:107], v[172:175], a[56:59], a[104:107]
v_mfma_f32_16x16x32_bf16 a[124:127], v[172:175], a[60:63], a[124:127]
v_mfma_f32_16x16x32_bf16 a[68:71], v[176:179], a[48:51], a[68:71]
v_mfma_f32_16x16x32_bf16 a[88:91], v[176:179], a[52:55], a[88:91]
v_mfma_f32_16x16x32_bf16 a[108:111], v[176:179], a[56:59], a[108:111]
v_mfma_f32_16x16x32_bf16 a[128:131], v[176:179], a[60:63], a[128:131]
v_mfma_f32_16x16x32_bf16 a[72:75], v[180:183], a[48:51], a[72:75]
v_mfma_f32_16x16x32_bf16 a[92:95], v[180:183], a[52:55], a[92:95]
v_mfma_f32_16x16x32_bf16 a[112:115], v[180:183], a[56:59], a[112:115]
v_mfma_f32_16x16x32_bf16 a[132:135], v[180:183], a[60:63], a[132:135]
v_mfma_f32_16x16x32_bf16 a[76:79], v[184:187], a[48:51], a[76:79]
v_mfma_f32_16x16x32_bf16 a[96:99], v[184:187], a[52:55], a[96:99]
v_mfma_f32_16x16x32_bf16 a[116:119], v[184:187], a[56:59], a[116:119]
v_mfma_f32_16x16x32_bf16 a[136:139], v[184:187], a[60:63], a[136:139]
v_mfma_f32_16x16x32_bf16 a[80:83], v[188:191], a[48:51], a[80:83]
v_mfma_f32_16x16x32_bf16 a[100:103], v[188:191], a[52:55], a[100:103]
v_mfma_f32_16x16x32_bf16 a[120:123], v[188:191], a[56:59], a[120:123]
v_mfma_f32_16x16x32_bf16 a[140:143], v[188:191], a[60:63], a[140:143]
s_waitcnt vmcnt(3)
v_cmp_gt_u32 vcc, 16, v28
s_nop 4
s_cbranch_vccz l2_kernel_pb_fast
s_mov_b32 s7, 0
l2_kernel_pb_retry:
v_mov_b32 v24, 0
buffer_load_dword v25, v24, s[8:11], s82 offen sc1
s_waitcnt vmcnt(0)
v_cmp_gt_u32 vcc, 16, v25
s_nop 4
s_cbranch_vccz l2_kernel_pb_ok
s_add_u32 s7, s7, 1
s_cmp_lt_u32 s7, 400000
s_cbranch_scc0 l2_kernel_pb_ok
s_branch l2_kernel_pb_retry
l2_kernel_pb_ok:
l2_kernel_pb_fast:
v_lshl_add_u32 v5, s49, 10, v1
buffer_load_dwordx4 a[16:19], v5, s[8:11], s56 offen sc1
buffer_load_dwordx4 a[20:23], v5, s[8:11], s57 offen sc1
buffer_load_dwordx4 a[24:27], v5, s[8:11], s58 offen sc1
buffer_load_dwordx4 a[28:31], v5, s[8:11], s59 offen sc1
s_waitcnt vmcnt(4)
v_mfma_f32_16x16x32_bf16 a[64:67], v[192:195], a[0:3], a[64:67]
v_mfma_f32_16x16x32_bf16 a[84:87], v[192:195], a[4:7], a[84:87]
v_lshl_add_u32 v4, s50, 10, v1
buffer_load_dwordx4 a[32:35], v4, s[8:11], s56 offen sc1
v_mfma_f32_16x16x32_bf16 a[104:107], v[192:195], a[8:11], a[104:107]
v_mfma_f32_16x16x32_bf16 a[124:127], v[192:195], a[12:15], a[124:127]
v_mfma_f32_16x16x32_bf16 a[68:71], v[196:199], a[0:3], a[68:71]
v_mfma_f32_16x16x32_bf16 a[88:91], v[196:199], a[4:7], a[88:91]
buffer_load_dwordx4 a[36:39], v4, s[8:11], s57 offen sc1
v_mfma_f32_16x16x32_bf16 a[108:111], v[196:199], a[8:11], a[108:111]
v_mfma_f32_16x16x32_bf16 a[128:131], v[196:199], a[12:15], a[128:131]
v_mfma_f32_16x16x32_bf16 a[72:75], v[200:203], a[0:3], a[72:75]
v_mfma_f32_16x16x32_bf16 a[92:95], v[200:203], a[4:7], a[92:95]
buffer_load_dwordx4 a[40:43], v4, s[8:11], s58 offen sc1
v_mfma_f32_16x16x32_bf16 a[112:115], v[200:203], a[8:11], a[112:115]
v_mfma_f32_16x16x32_bf16 a[132:135], v[200:203], a[12:15], a[132:135]
v_mfma_f32_16x16x32_bf16 a[76:79], v[204:207], a[0:3], a[76:79]
v_mfma_f32_16x16x32_bf16 a[96:99], v[204:207], a[4:7], a[96:99]
buffer_load_dwordx4 a[44:47], v4, s[8:11], s59 offen sc1
v_mfma_f32_16x16x32_bf16 a[116:119], v[204:207], a[8:11], a[116:119]
v_mfma_f32_16x16x32_bf16 a[136:139], v[204:207], a[12:15], a[136:139]
v_mfma_f32_16x16x32_bf16 a[80:83], v[208:211], a[0:3], a[80:83]
v_mfma_f32_16x16x32_bf16 a[100:103], v[208:211], a[4:7], a[100:103]
v_lshl_add_u32 v5, s51, 10, v1
buffer_load_dwordx4 a[48:51], v5, s[8:11], s56 offen sc1
v_mfma_f32_16x16x32_bf16 a[120:123], v[208:211], a[8:11], a[120:123]
v_mfma_f32_16x16x32_bf16 a[140:143], v[208:211], a[12:15], a[140:143]
s_waitcnt vmcnt(5)
v_mfma_f32_16x16x32_bf16 a[64:67], v[212:215], a[16:19], a[64:67]
v_mfma_f32_16x16x32_bf16 a[84:87], v[212:215], a[20:23], a[84:87]
buffer_load_dwordx4 a[52:55], v5, s[8:11], s57 offen sc1
v_mfma_f32_16x16x32_bf16 a[104:107], v[212:215], a[24:27], a[104:107]
v_mfma_f32_16x16x32_bf16 a[124:127], v[212:215], a[28:31], a[124:127]
v_mfma_f32_16x16x32_bf16 a[68:71], v[216:219], a[16:19], a[68:71]
v_mfma_f32_16x16x32_bf16 a[88:91], v[216:219], a[20:23], a[88:91]
buffer_load_dwordx4 a[56:59], v5, s[8:11], s58 offen sc1
v_mfma_f32_16x16x32_bf16 a[108:111], v[216:219], a[24:27], a[108:111]
v_mfma_f32_16x16x32_bf16 a[128:131], v[216:219], a[28:31], a[128:131]
v_mfma_f32_16x16x32_bf16 a[72:75], v[220:223], a[16:19], a[72:75]
v_mfma_f32_16x16x32_bf16 a[92:95], v[220:223], a[20:23], a[92:95]
buffer_load_dwordx4 a[60:63], v5, s[8:11], s59 offen sc1
v_mfma_f32_16x16x32_bf16 a[112:115], v[220:223], a[24:27], a[112:115]
v_mfma_f32_16x16x32_bf16 a[132:135], v[220:223], a[28:31], a[132:135]
v_mfma_f32_16x16x32_bf16 a[76:79], v[224:227], a[16:19], a[76:79]
v_mfma_f32_16x16x32_bf16 a[96:99], v[224:227], a[20:23], a[96:99]
v_lshl_add_u32 v4, s52, 10, v1
buffer_load_dwordx4 a[0:3], v4, s[8:11], s56 offen sc1
v_mfma_f32_16x16x32_bf16 a[116:119], v[224:227], a[24:27], a[116:119]
v_mfma_f32_16x16x32_bf16 a[136:139], v[224:227], a[28:31], a[136:139]
v_mfma_f32_16x16x32_bf16 a[80:83], v[228:231], a[16:19], a[80:83]
v_mfma_f32_16x16x32_bf16 a[100:103], v[228:231], a[20:23], a[100:103]
buffer_load_dwordx4 a[4:7], v4, s[8:11], s57 offen sc1
v_mfma_f32_16x16x32_bf16 a[120:123], v[228:231], a[24:27], a[120:123]
v_mfma_f32_16x16x32_bf16 a[140:143], v[228:231], a[28:31], a[140:143]
s_waitcnt vmcnt(6)
v_mfma_f32_16x16x32_bf16 a[64:67], v[232:235], a[32:35], a[64:67]
v_mfma_f32_16x16x32_bf16 a[84:87], v[232:235], a[36:39], a[84:87]
buffer_load_dwordx4 a[8:11], v4, s[8:11], s58 offen sc1
v_mfma_f32_16x16x32_bf16 a[104:107], v[232:235], a[40:43], a[104:107]
v_mfma_f32_16x16x32_bf16 a[124:127], v[232:235], a[44:47], a[124:127]
v_mfma_f32_16x16x32_bf16 a[68:71], v[236:239], a[32:35], a[68:71]
v_mfma_f32_16x16x32_bf16 a[88:91], v[236:239], a[36:39], a[88:91]
buffer_load_dwordx4 a[12:15], v4, s[8:11], s59 offen sc1
v_mfma_f32_16x16x32_bf16 a[108:111], v[236:239], a[40:43], a[108:111]
v_mfma_f32_16x16x32_bf16 a[128:131], v[236:239], a[44:47], a[128:131]
v_mfma_f32_16x16x32_bf16 a[72:75], v[240:243], a[32:35], a[72:75]
v_mfma_f32_16x16x32_bf16 a[92:95], v[240:243], a[36:39], a[92:95]
v_lshl_add_u32 v5, s53, 10, v1
buffer_load_dwordx4 a[16:19], v5, s[8:11], s56 offen sc1
v_mfma_f32_16x16x32_bf16 a[112:115], v[240:243], a[40:43], a[112:115]
v_mfma_f32_16x16x32_bf16 a[132:135], v[240:243], a[44:47], a[132:135]
v_mfma_f32_16x16x32_bf16 a[76:79], v[244:247], a[32:35], a[76:79]
v_mfma_f32_16x16x32_bf16 a[96:99], v[244:247], a[36:39], a[96:99]
buffer_load_dwordx4 a[20:23], v5, s[8:11], s57 offen sc1
v_mfma_f32_16x16x32_bf16 a[116:119], v[244:247], a[40:43], a[116:119]
v_mfma_f32_16x16x32_bf16 a[136:139], v[244:247], a[44:47], a[136:139]
v_mfma_f32_16x16x32_bf16 a[80:83], v[248:251], a[32:35], a[80:83]
v_mfma_f32_16x16x32_bf16 a[100:103], v[248:251], a[36:39], a[100:103]
buffer_load_dwordx4 a[24:27], v5, s[8:11], s58 offen sc1
v_mfma_f32_16x16x32_bf16 a[120:123], v[248:251], a[40:43], a[120:123]
v_mfma_f32_16x16x32_bf16 a[140:143], v[248:251], a[44:47], a[140:143]
s_waitcnt vmcnt(7)
v_mfma_f32_16x16x32_bf16 a[64:67], v[252:255], a[48:51], a[64:67]
v_mfma_f32_16x16x32_bf16 a[84:87], v[252:255], a[52:55], a[84:87]
buffer_load_dwordx4 a[28:31], v5, s[8:11], s59 offen sc1
v_mfma_f32_16x16x32_bf16 a[104:107], v[252:255], a[56:59], a[104:107]
v_mfma_f32_16x16x32_bf16 a[124:127], v[252:255], a[60:63], a[124:127]
v_mfma_f32_16x16x32_bf16 a[68:71], v[32:35], a[48:51], a[68:71]
v_mfma_f32_16x16x32_bf16 a[88:91], v[32:35], a[52:55], a[88:91]
v_mfma_f32_16x16x32_bf16 a[108:111], v[32:35], a[56:59], a[108:111]
v_mfma_f32_16x16x32_bf16 a[128:131], v[32:35], a[60:63], a[128:131]
v_mfma_f32_16x16x32_bf16 a[72:75], v[36:39], a[48:51], a[72:75]
v_mfma_f32_16x16x32_bf16 a[92:95], v[36:39], a[52:55], a[92:95]
v_mfma_f32_16x16x32_bf16 a[112:115], v[36:39], a[56:59], a[112:115]
v_mfma_f32_16x16x32_bf16 a[132:135], v[36:39], a[60:63], a[132:135]
v_mfma_f32_16x16x32_bf16 a[76:79], v[40:43], a[48:51], a[76:79]
v_mfma_f32_16x16x32_bf16 a[96:99], v[40:43], a[52:55], a[96:99]
v_mfma_f32_16x16x32_bf16 a[116:119], v[40:43], a[56:59], a[116:119]
v_mfma_f32_16x16x32_bf16 a[136:139], v[40:43], a[60:63], a[136:139]
v_mfma_f32_16x16x32_bf16 a[80:83], v[44:47], a[48:51], a[80:83]
v_mfma_f32_16x16x32_bf16 a[100:103], v[44:47], a[52:55], a[100:103]
v_mfma_f32_16x16x32_bf16 a[120:123], v[44:47], a[56:59], a[120:123]
v_mfma_f32_16x16x32_bf16 a[140:143], v[44:47], a[60:63], a[140:143]
s_waitcnt vmcnt(4)
v_mfma_f32_16x16x32_bf16 a[64:67], v[48:51], a[0:3], a[64:67]
v_mfma_f32_16x16x32_bf16 a[84:87], v[48:51], a[4:7], a[84:87]
v_mfma_f32_16x16x32_bf16 a[104:107], v[48:51], a[8:11], a[104:107]
v_mfma_f32_16x16x32_bf16 a[124:127], v[48:51], a[12:15], a[124:127]
v_mfma_f32_16x16x32_bf16 a[68:71], v[52:55], a[0:3], a[68:71]
v_mfma_f32_16x16x32_bf16 a[88:91], v[52:55], a[4:7], a[88:91]
v_mfma_f32_16x16x32_bf16 a[108:111], v[52:55], a[8:11], a[108:111]
v_mfma_f32_16x16x32_bf16 a[128:131], v[52:55], a[12:15], a[128:131]
v_mfma_f32_16x16x32_bf16 a[72:75], v[56:59], a[0:3], a[72:75]
v_mfma_f32_16x16x32_bf16 a[92:95], v[56:59], a[4:7], a[92:95]
v_mfma_f32_16x16x32_bf16 a[112:115], v[56:59], a[8:11], a[112:115]
v_mfma_f32_16x16x32_bf16 a[132:135], v[56:59], a[12:15], a[132:135]
v_mfma_f32_16x16x32_bf16 a[76:79], v[60:63], a[0:3], a[76:79]
v_mfma_f32_16x16x32_bf16 a[96:99], v[60:63], a[4:7], a[96:99]
v_mfma_f32_16x16x32_bf16 a[116:119], v[60:63], a[8:11], a[116:119]
v_mfma_f32_16x16x32_bf16 a[136:139], v[60:63], a[12:15], a[136:139]
v_mfma_f32_16x16x32_bf16 a[80:83], v[64:67], a[0:3], a[80:83]
v_mfma_f32_16x16x32_bf16 a[100:103], v[64:67], a[4:7], a[100:103]
v_mfma_f32_16x16x32_bf16 a[120:123], v[64:67], a[8:11], a[120:123]
v_mfma_f32_16x16x32_bf16 a[140:143], v[64:67], a[12:15], a[140:143]
s_waitcnt vmcnt(0)
s_cmp_ge_u32 s20, 2
s_cbranch_scc1 l2_kernel_skip13
v_mfma_f32_16x16x32_bf16 a[64:67], v[68:71], a[16:19], a[64:67]
v_mfma_f32_16x16x32_bf16 a[84:87], v[68:71], a[20:23], a[84:87]
v_mfma_f32_16x16x32_bf16 a[104:107], v[68:71], a[24:27], a[104:107]
v_mfma_f32_16x16x32_bf16 a[124:127], v[68:71], a[28:31], a[124:127]
v_mfma_f32_16x16x32_bf16 a[68:71], v[72:75], a[16:19], a[68:71]
v_mfma_f32_16x16x32_bf16 a[88:91], v[72:75], a[20:23], a[88:91]
v_mfma_f32_16x16x32_bf16 a[108:111], v[72:75], a[24:27], a[108:111]
v_mfma_f32_16x16x32_bf16 a[128:131], v[72:75], a[28:31], a[128:131]
v_mfma_f32_16x16x32_bf16 a[72:75], v[76:79], a[16:19], a[72:75]
v_mfma_f32_16x16x32_bf16 a[92:95], v[76:79], a[20:23], a[92:95]
v_mfma_f32_16x16x32_bf16 a[112:115], v[76:79], a[24:27], a[112:115]
v_mfma_f32_16x16x32_bf16 a[132:135], v[76:79], a[28:31], a[132:135]
v_mfma_f32_16x16x32_bf16 a[76:79], v[80:83], a[16:19], a[76:79]
v_mfma_f32_16x16x32_bf16 a[96:99], v[80:83], a[20:23], a[96:99]
v_mfma_f32_16x16x32_bf16 a[116:119], v[80:83], a[24:27], a[116:119]
v_mfma_f32_16x16x32_bf16 a[136:139], v[80:83], a[28:31], a[136:139]
v_mfma_f32_16x16x32_bf16 a[80:83], v[84:87], a[16:19], a[80:83]
v_mfma_f32_16x16x32_bf16 a[100:103], v[84:87], a[20:23], a[100:103]
v_mfma_f32_16x16x32_bf16 a[120:123], v[84:87], a[24:27], a[120:123]
v_mfma_f32_16x16x32_bf16 a[140:143], v[84:87], a[28:31], a[140:143]
l2_kernel_skip13:
buffer_load_dwordx4 v[112:115], v14, s[8:11], s60 offen sc1
buffer_load_dwordx4 v[116:119], v14, s[8:11], s60 offen offset:2048 sc1
buffer_load_dwordx2 v[120:121], v15, s[8:11], s61 offen sc1
s_add_u32 s3, s20, 1
s_and_b32 s3, s3, 3
s_mul_i32 s3, s3, 15360
s_add_u32 s3, s3, 0
v_add_u32 v5, s3, v1
ds_write_b128 v5, a[84:87] offset:0
ds_write_b128 v5, a[88:91] offset:1024
ds_write_b128 v5, a[92:95] offset:2048
ds_write_b128 v5, a[96:99] offset:3072
ds_write_b128 v5, a[100:103] offset:4096
s_add_u32 s3, s20, 2
s_and_b32 s3, s3, 3
s_mul_i32 s3, s3, 15360
s_add_u32 s3, s3, 5120
v_add_u32 v6, s3, v1
ds_write_b128 v6, a[104:107] offset:0
ds_write_b128 v6, a[108:111] offset:1024
ds_write_b128 v6, a[112:115] offset:2048
ds_write_b128 v6, a[116:119] offset:3072
ds_write_b128 v6, a[120:123] offset:4096
s_add_u32 s3, s20, 3
s_and_b32 s3, s3, 3
s_mul_i32 s3, s3, 15360
s_add_u32 s3, s3, 10240
v_add_u32 v7, s3, v1
ds_write_b128 v7, a[124:127] offset:0
ds_write_b128 v7, a[128:131] offset:1024
ds_write_b128 v7, a[132:135] offset:2048
ds_write_b128 v7, a[136:139] offset:3072
ds_write_b128 v7, a[140:143] offset:4096
s_waitcnt lgkmcnt(0)
s_barrier
s_mul_i32 s3, s20, 15360
s_add_u32 s3, s3, 0
v_add_u32 v4, s3, v1
v_accvgpr_read_b32 v32, a64
v_accvgpr_read_b32 v33, a65
v_accvgpr_read_b32 v34, a66
v_accvgpr_read_b32 v35, a67
v_accvgpr_read_b32 v36, a68
v_accvgpr_read_b32 v37, a69
v_accvgpr_read_b32 v38, a70
v_accvgpr_read_b32 v39, a71
v_accvgpr_read_b32 v40, a72
v_accvgpr_read_b32 v41, a73
v_accvgpr_read_b32 v42, a74
v_accvgpr_read_b32 v43, a75
v_accvgpr_read_b32 v44, a76
v_accvgpr_read_b32 v45, a77
v_accvgpr_read_b32 v46, a78
v_accvgpr_read_b32 v47, a79
v_accvgpr_read_b32 v48, a80
v_accvgpr_read_b32 v49, a81
v_accvgpr_read_b32 v50, a82
v_accvgpr_read_b32 v51, a83
ds_read_b128 v[52:55], v4 offset:0
ds_read_b128 v[56:59], v4 offset:1024
ds_read_b128 v[60:63], v4 offset:2048
ds_read_b128 v[64:67], v4 offset:3072
ds_read_b128 v[68:71], v4 offset:4096
ds_read_b128 v[72:75], v4 offset:5120
ds_read_b128 v[76:79], v4 offset:6144
ds_read_b128 v[80:83], v4 offset:7168
ds_read_b128 v[84:87], v4 offset:8192
ds_read_b128 v[88:91], v4 offset:9216
ds_read_b128 v[92:95], v4 offset:10240
ds_read_b128 v[96:99], v4 offset:11264
ds_read_b128 v[100:103], v4 offset:12288
ds_read_b128 v[104:107], v4 offset:13312
ds_read_b128 v[108:111], v4 offset:14336
s_waitcnt lgkmcnt(10)
v_add_f32 v32, v32, v52
v_add_f32 v33, v33, v53
v_add_f32 v34, v34, v54
v_add_f32 v35, v35, v55
v_add_f32 v36, v36, v56
v_add_f32 v37, v37, v57
v_add_f32 v38, v38, v58
v_add_f32 v39, v39, v59
v_add_f32 v40, v40, v60
v_add_f32 v41, v41, v61
v_add_f32 v42, v42, v62
v_add_f32 v43, v43, v63
v_add_f32 v44, v44, v64
v_add_f32 v45, v45, v65
v_add_f32 v46, v46, v66
v_add_f32 v47, v47, v67
v_add_f32 v48, v48, v68
v_add_f32 v49, v49, v69
v_add_f32 v50, v50, v70
v_add_f32 v51, v51, v71
s_waitcnt lgkmcnt(5)
v_add_f32 v32, v32, v72
v_add_f32 v33, v33, v73
v_add_f32 v34, v34, v74
v_add_f32 v35, v35, v75
v_add_f32 v36, v36, v76
v_add_f32 v37, v37, v77
v_add_f32 v38, v38, v78
v_add_f32 v39, v39, v79
v_add_f32 v40, v40, v80
v_add_f32 v41, v41, v81
v_add_f32 v42, v42, v82
v_add_f32 v43, v43, v83
v_add_f32 v44, v44, v84
v_add_f32 v45, v45, v85
v_add_f32 v46, v46, v86
v_add_f32 v47, v47, v87
v_add_f32 v48, v48, v88
v_add_f32 v49, v49, v89
v_add_f32 v50, v50, v90
v_add_f32 v51, v51, v91
s_waitcnt lgkmcnt(0)
v_add_f32 v32, v32, v92
v_add_f32 v33, v33, v93
v_add_f32 v34, v34, v94
v_add_f32 v35, v35, v95
v_add_f32 v36, v36, v96
v_add_f32 v37, v37, v97
v_add_f32 v38, v38, v98
v_add_f32 v39, v39, v99
v_add_f32 v40, v40, v100
v_add_f32 v41, v41, v101
v_add_f32 v42, v42, v102
v_add_f32 v43, v43, v103
v_add_f32 v44, v44, v104
v_add_f32 v45, v45, v105
v_add_f32 v46, v46, v106
v_add_f32 v47, v47, v107
v_add_f32 v48, v48, v108
v_add_f32 v49, v49, v109
v_add_f32 v50, v50, v110
v_add_f32 v51, v51, v111
s_cmp_eq_u32 s67, 1
s_cbranch_scc1 l2_kernel_final
s_waitcnt vmcnt(0)
v_lshlrev_b32 v16, 16, v112
v_and_b32 v17, 0xffff0000, v112
v_add_f32 v16, v16, v32
v_add_f32 v17, v17, v33
v_cvt_pk_bf16_f32 v112, v16, v17
v_lshlrev_b32 v16, 16, v113
v_and_b32 v17, 0xffff0000, v113
v_add_f32 v16, v16, v34
v_add_f32 v17, v17, v35
v_cvt_pk_bf16_f32 v113, v16, v17
v_lshlrev_b32 v16, 16, v114
v_and_b32 v17, 0xffff0000, v114
v_add_f32 v16, v16, v36
v_add_f32 v17, v17, v37
v_cvt_pk_bf16_f32 v114, v16, v17
v_lshlrev_b32 v16, 16, v115
v_and_b32 v17, 0xffff0000, v115
v_add_f32 v16, v16, v38
v_add_f32 v17, v17, v39
v_cvt_pk_bf16_f32 v115, v16, v17
v_lshlrev_b32 v16, 16, v116
v_and_b32 v17, 0xffff0000, v116
v_add_f32 v16, v16, v40
v_add_f32 v17, v17, v41
v_cvt_pk_bf16_f32 v116, v16, v17
v_lshlrev_b32 v16, 16, v117
v_and_b32 v17, 0xffff0000, v117
v_add_f32 v16, v16, v42
v_add_f32 v17, v17, v43
v_cvt_pk_bf16_f32 v117, v16, v17
v_lshlrev_b32 v16, 16, v118
v_and_b32 v17, 0xffff0000, v118
v_add_f32 v16, v16, v44
v_add_f32 v17, v17, v45
v_cvt_pk_bf16_f32 v118, v16, v17
v_lshlrev_b32 v16, 16, v119
v_and_b32 v17, 0xffff0000, v119
v_add_f32 v16, v16, v46
v_add_f32 v17, v17, v47
v_cvt_pk_bf16_f32 v119, v16, v17
v_lshlrev_b32 v16, 16, v120
v_and_b32 v17, 0xffff0000, v120
v_add_f32 v16, v16, v48
v_add_f32 v17, v17, v49
v_cvt_pk_bf16_f32 v120, v16, v17
v_lshlrev_b32 v16, 16, v121
v_and_b32 v17, 0xffff0000, v121
v_add_f32 v16, v16, v50
v_add_f32 v17, v17, v51
v_cvt_pk_bf16_f32 v121, v16, v17
buffer_store_dwordx4 v[112:115], v14, s[8:11], s62 offen sc1
buffer_store_dwordx4 v[116:119], v14, s[8:11], s62 offen offset:2048 sc1
buffer_store_dwordx2 v[120:121], v15, s[8:11], s63 offen sc1
v_mov_b32 v18, 0
v_mov_b32 v19, 0
v_mov_b32 v20, 0x3f803f80
v_dot2c_f32_bf16 v18, v112, v20
v_dot2c_f32_bf16 v19, v112, v112
v_dot2c_f32_bf16 v18, v113, v20
v_dot2c_f32_bf16 v19, v113, v113
v_dot2c_f32_bf16 v18, v114, v20
v_dot2c_f32_bf16 v19, v114, v114
v_dot2c_f32_bf16 v18, v115, v20
v_dot2c_f32_bf16 v19, v115, v115
v_dot2c_f32_bf16 v18, v116, v20
v_dot2c_f32_bf16 v19, v116, v116
v_dot2c_f32_bf16 v18, v117, v20
v_dot2c_f32_bf16 v19, v117, v117
v_dot2c_f32_bf16 v18, v118, v20
v_dot2c_f32_bf16 v19, v118, v118
v_dot2c_f32_bf16 v18, v119, v20
v_dot2c_f32_bf16 v19, v119, v119
v_dot2c_f32_bf16 v18, v120, v20
v_dot2c_f32_bf16 v19, v120, v120
v_dot2c_f32_bf16 v18, v121, v20
v_dot2c_f32_bf16 v19, v121, v121
s_nop 1
v_mov_b32 v16, v18
s_nop 1
v_permlane16_swap_b32 v16, v18
v_add_f32 v18, v18, v16
v_mov_b32 v16, v18
s_nop 1
v_permlane32_swap_b32 v16, v18
v_add_f32 v18, v18, v16
v_mov_b32 v16, v19
s_nop 1
v_permlane16_swap_b32 v16, v19
v_add_f32 v19, v19, v16
v_mov_b32 v16, v19
s_nop 1
v_permlane32_swap_b32 v16, v19
v_add_f32 v19, v19, v16
v_lshlrev_b32 v17, 3, v13
v_cmp_eq_u32 vcc, 0, v3
s_nop 3
s_and_saveexec_b64 s[6:7], vcc
buffer_store_dwordx2 v[18:19], v17, s[8:11], s64 offen sc1
s_mov_b64 exec, s[6:7]
v_and_b32 v254, 31, v0
v_bfe_u32 v255, v0, 5, 1
v_cvt_f32_u32 v4, v254
v_mul_f32 v4, 0x3a000000, v4
v_lshlrev_b32 v5, 8, v255
v_add_u32 v5, s72, v5
v_cvt_f32_u32 v5, v5
v_mul_f32 v5, v4, v5
v_mul_f32 v4, 0x42800000, v4
v_mov_b32 v8, 0x0
v_fma_f32 v6, v8, v4, v5
v_mov_b32 v8, 0x3f800000
v_fma_f32 v7, v8, v4, v5
v_cos_f32 v8, v6
v_cos_f32 v9, v7
v_sin_f32 v10, -v6
v_sin_f32 v11, -v7
v_cvt_pk_f16_f32 v16, v8, v9
v_cvt_pk_f16_f32 v24, v10, v11
v_mov_b32 v8, 0x40000000
v_fma_f32 v6, v8, v4, v5
v_mov_b32 v8, 0x40400000
v_fma_f32 v7, v8, v4, v5
v_cos_f32 v8, v6
v_cos_f32 v9, v7
v_sin_f32 v10, -v6
v_sin_f32 v11, -v7
v_cvt_pk_f16_f32 v17, v8, v9
v_cvt_pk_f16_f32 v25, v10, v11
v_mov_b32 v8, 0x41000000
v_fma_f32 v6, v8, v4, v5
v_mov_b32 v8, 0x41100000
v_fma_f32 v7, v8, v4, v5
v_cos_f32 v8, v6
v_cos_f32 v9, v7
v_sin_f32 v10, -v6
v_sin_f32 v11, -v7
v_cvt_pk_f16_f32 v18, v8, v9
v_cvt_pk_f16_f32 v26, v10, v11
v_mov_b32 v8, 0x41200000
v_fma_f32 v6, v8, v4, v5
v_mov_b32 v8, 0x41300000
v_fma_f32 v7, v8, v4, v5
v_cos_f32 v8, v6
v_cos_f32 v9, v7
v_sin_f32 v10, -v6
v_sin_f32 v11, -v7
v_cvt_pk_f16_f32 v19, v8, v9
v_cvt_pk_f16_f32 v27, v10, v11
v_mov_b32 v8, 0x41800000
v_fma_f32 v6, v8, v4, v5
v_mov_b32 v8, 0x41880000
v_fma_f32 v7, v8, v4, v5
v_cos_f32 v8, v6
v_cos_f32 v9, v7
v_sin_f32 v10, -v6
v_sin_f32 v11, -v7
v_cvt_pk_f16_f32 v20, v8, v9
v_cvt_pk_f16_f32 v28, v10, v11
v_mov_b32 v8, 0x41900000
v_fma_f32 v6, v8, v4, v5
v_mov_b32 v8, 0x41980000
v_fma_f32 v7, v8, v4, v5
v_cos_f32 v8, v6
v_cos_f32 v9, v7
v_sin_f32 v10, -v6
v_sin_f32 v11, -v7
v_cvt_pk_f16_f32 v21, v8, v9
v_cvt_pk_f16_f32 v29, v10, v11
v_mov_b32 v8, 0x41c00000
v_fma_f32 v6, v8, v4, v5
v_mov_b32 v8, 0x41c80000
v_fma_f32 v7, v8, v4, v5
v_cos_f32 v8, v6
v_cos_f32 v9, v7
v_sin_f32 v10, -v6
v_sin_f32 v11, -v7
v_cvt_pk_f16_f32 v22, v8, v9
v_cvt_pk_f16_f32 v30, v10, v11
v_mov_b32 v8, 0x41d00000
v_fma_f32 v6, v8, v4, v5
v_mov_b32 v8, 0x41d80000
v_fma_f32 v7, v8, v4, v5
v_cos_f32 v8, v6
v_cos_f32 v9, v7
v_sin_f32 v10, -v6
v_sin_f32 v11, -v7
v_cvt_pk_f16_f32 v23, v8, v9
v_cvt_pk_f16_f32 v31, v10, v11
v_and_b32 v4, 0x31, v0
v_cmp_eq_u32 vcc, 1, v4
v_mov_b32 v5, 0xc000
v_mov_b32 v6, 0xbf00
v_cndmask_b32 v228, 0, v5, vcc
v_cndmask_b32 v232, 0, v6, vcc
v_mov_b32 v229, 0
v_mov_b32 v233, 0
v_mov_b32 v230, 0
v_mov_b32 v234, 0
v_mov_b32 v231, 0
v_mov_b32 v235, 0
v_mov_b32 v253, v1
s_add_u32 s3, s20, 0
s_and_b32 s3, s3, 3
s_mul_i32 s3, s3, 5120
v_add_u32 v236, s3, v253
s_add_u32 s3, s20, 1
s_and_b32 s3, s3, 3
s_mul_i32 s3, s3, 5120
v_add_u32 v237, s3, v253
s_add_u32 s3, s20, 2
s_and_b32 s3, s3, 3
s_mul_i32 s3, s3, 5120
v_add_u32 v238, s3, v253
s_add_u32 s3, s20, 3
s_and_b32 s3, s3, 3
s_mul_i32 s3, s3, 5120
v_add_u32 v239, s3, v253
s_waitcnt vmcnt(0)
s_barrier
s_cmp_lg_u32 s20, 0
s_cbranch_scc1 l2_kernel_sigC
s_lshl_b32 s3, s22, 2
v_mov_b32 v10, s3
v_mov_b32 v11, 1
s_mov_b64 exec, 1
v_mov_b32 v10, 0
buffer_atomic_add v11, v10, s[8:11], s83 offen sc1
s_mov_b64 exec, -1
l2_kernel_sigC:
s_lshl_b32 s3, s71, 2
s_add_u32 s3, s3, s20
s_lshl_b32 s3, s3, 9
s_add_u32 s3, s3, 45498368
v_lshrrev_b32 v13, 2, v1
buffer_load_dword v251, v13, s[8:11], s3 offen
buffer_load_dword v252, v13, s[8:11], s3 offen offset:256
s_lshl_b32 s12, s71, 2
s_add_u32 s12, s12, s20
s_mul_i32 s12, s12, 25600
s_add_u32 s12, s12, 45088768
buffer_load_dwordx4 v[128:131], v1, s[8:11], s12 offen offset:0
buffer_load_dwordx4 v[132:135], v1, s[8:11], s12 offen offset:1024
buffer_load_dwordx4 v[136:139], v1, s[8:11], s12 offen offset:2048
buffer_load_dwordx4 v[140:143], v1, s[8:11], s12 offen offset:3072
s_add_u32 s12, s12, 4096
buffer_load_dwordx4 v[144:147], v1, s[8:11], s12 offen offset:0
buffer_load_dwordx4 v[148:151], v1, s[8:11], s12 offen offset:1024
buffer_load_dwordx4 v[152:155], v1, s[8:11], s12 offen offset:2048
buffer_load_dwordx4 v[156:159], v1, s[8:11], s12 offen offset:3072
s_add_u32 s12, s12, 4096
buffer_load_dwordx4 v[160:163], v1, s[8:11], s12 offen offset:0
buffer_load_dwordx4 v[164:167], v1, s[8:11], s12 offen offset:1024
buffer_load_dwordx4 v[168:171], v1, s[8:11], s12 offen offset:2048
buffer_load_dwordx4 v[172:175], v1, s[8:11], s12 offen offset:3072
s_add_u32 s12, s12, 4096
buffer_load_dwordx4 v[176:179], v1, s[8:11], s12 offen offset:0
buffer_load_dwordx4 v[180:183], v1, s[8:11], s12 offen offset:1024
buffer_load_dwordx4 v[184:187], v1, s[8:11], s12 offen offset:2048
buffer_load_dwordx4 v[188:191], v1, s[8:11], s12 offen offset:3072
s_add_u32 s12, s12, 4096
buffer_load_dwordx4 v[192:195], v1, s[8:11], s12 offen offset:0
v_mov_b32 v13, 0
buffer_load_dword v14, v13, s[8:11], s83 offen sc1
buffer_load_dwordx4 v[196:199], v1, s[8:11], s12 offen offset:1024
buffer_load_dwordx4 v[200:203], v1, s[8:11], s12 offen offset:2048
buffer_load_dwordx4 v[204:207], v1, s[8:11], s12 offen offset:3072
s_add_u32 s12, s12, 4096
buffer_load_dwordx4 v[208:211], v1, s[8:11], s12 offen offset:0
buffer_load_dwordx4 v[212:215], v1, s[8:11], s12 offen offset:1024
buffer_load_dwordx4 v[216:219], v1, s[8:11], s12 offen offset:2048
buffer_load_dwordx4 v[220:223], v1, s[8:11], s12 offen offset:3072
s_add_u32 s12, s12, 4096
buffer_load_dwordx4 v[224:227], v1, s[8:11], s12 offen offset:0
s_waitcnt vmcnt(8)
v_cmp_gt_u32 vcc, 16, v14
s_nop 4
s_cbranch_vccz l2_kernel_pcfast
s_mov_b32 s7, 0
l2_kernel_pc_retry:
v_mov_b32 v10, 0
buffer_load_dword v11, v10, s[8:11], s83 offen sc1
s_waitcnt vmcnt(0)
v_cmp_gt_u32 vcc, 16, v11
s_nop 4
s_cbranch_vccz l2_kernel_pc_ok
s_add_u32 s7, s7, 1
s_cmp_lt_u32 s7, 400000
s_cbranch_scc0 l2_kernel_pc_ok
s_branch l2_kernel_pc_retry
l2_kernel_pc_ok:
l2_kernel_pcfast:
s_mul_i32 s3, s70, 40960
s_mul_i32 s4, s20, 5120
s_add_u32 s3, s3, s4
s_add_u32 s3, s3, 6291456
s_add_u32 s4, s3, 20480
s_add_u32 s5, s3, 4096
s_add_u32 s6, s4, 4096
s_lshl_b32 s7, s70, 11
s_add_u32 s7, s7, 42991616
v_lshlrev_b32 v4, 10, v255
v_lshl_add_u32 v4, v254, 3, v4
buffer_load_dwordx2 v[32:33], v4, s[8:11], s7 offen offset:0 sc1
buffer_load_dwordx2 v[34:35], v4, s[8:11], s7 offen offset:256 sc1
buffer_load_dwordx2 v[36:37], v4, s[8:11], s7 offen offset:512 sc1
buffer_load_dwordx2 v[38:39], v4, s[8:11], s7 offen offset:768 sc1
buffer_load_dwordx4 v[64:67], v1, s[8:11], s3 offen offset:0 sc1
buffer_load_dwordx4 v[84:87], v1, s[8:11], s4 offen offset:0 sc1
buffer_load_dwordx4 v[68:71], v1, s[8:11], s3 offen offset:1024 sc1
buffer_load_dwordx4 v[88:91], v1, s[8:11], s4 offen offset:1024 sc1
buffer_load_dwordx4 v[72:75], v1, s[8:11], s3 offen offset:2048 sc1
buffer_load_dwordx4 v[92:95], v1, s[8:11], s4 offen offset:2048 sc1
buffer_load_dwordx4 v[76:79], v1, s[8:11], s3 offen offset:3072 sc1
buffer_load_dwordx4 v[96:99], v1, s[8:11], s4 offen offset:3072 sc1
buffer_load_dwordx4 v[80:83], v1, s[8:11], s5 offen offset:0 sc1
buffer_load_dwordx4 v[100:103], v1, s[8:11], s6 offen offset:0 sc1
s_waitcnt vmcnt(10)
v_cmp_eq_u32 vcc, 0, v255
v_sub_f32 v4, 0, v251
s_nop 0
v_cndmask_b32 v4, 0, v4, vcc
v_and_b32 v5, 0xffff0000, v4
v_sub_f32 v6, v4, v5
v_cvt_pk_bf16_f32 v6, v6, v6
v_or_b32 v228, v228, v5
v_lshrrev_b32 v5, 16, v5
v_and_b32 v6, 0xffff0000, v6
v_or_b32 v229, v5, v6
v_sub_f32 v4, 0, v252
v_cndmask_b32 v4, 0, v4, vcc
v_and_b32 v5, 0xffff0000, v4
v_sub_f32 v6, v4, v5
v_cvt_pk_bf16_f32 v6, v6, v6
v_or_b32 v232, v232, v5
v_lshrrev_b32 v5, 16, v5
v_and_b32 v6, 0xffff0000, v6
v_or_b32 v233, v5, v6
v_add_f32 v32, v32, v34
v_add_f32 v33, v33, v35
v_add_f32 v32, v32, v36
v_add_f32 v33, v33, v37
v_add_f32 v32, v32, v38
v_add_f32 v33, v33, v39
v_mov_b32 v4, v32
s_nop 1
v_permlane32_swap_b32 v4, v32
v_add_f32 v32, v32, v4
v_mov_b32 v4, v33
s_nop 1
v_permlane32_swap_b32 v4, v33
v_add_f32 v33, v33, v4
v_mul_f32 v32, 0x3acccccd, v32
v_mul_f32 v33, 0x3acccccd, v33
v_fma_f32 v33, -v32, v32, v33
v_max_f32 v33, 0, v33
v_add_f32 v33, 0x3727c5ac, v33
v_rsq_f32 v33, v33
s_lshl_b32 s3, s20, 7
s_add_u32 s3, s3, 40960
v_lshl_add_u32 v4, v254, 2, s3
ds_write_b32 v4, v33
v_and_b32 v249, 0xffff0000, v32
v_sub_f32 v4, v32, v249
v_cvt_pk_bf16_f32 v4, v4, v4
v_and_b32 v4, 0xffff, v4
v_or_b32 v250, v4, v249
s_waitcnt vmcnt(0)
ds_write_b128 v236, v[64:67] offset:0
ds_write_b128 v236, v[84:87] offset:20480
ds_write_b128 v236, v[68:71] offset:1024
ds_write_b128 v236, v[88:91] offset:21504
ds_write_b128 v236, v[72:75] offset:2048
ds_write_b128 v236, v[92:95] offset:22528
ds_write_b128 v236, v[76:79] offset:3072
ds_write_b128 v236, v[96:99] offset:23552
ds_write_b128 v236, v[80:83] offset:4096
ds_write_b128 v236, v[100:103] offset:24576
s_waitcnt lgkmcnt(0)
s_barrier
ds_read_b128 v[32:35], v236 offset:0
ds_read_b128 v[36:39], v236 offset:20480
ds_read_b128 v[40:43], v236 offset:1024
ds_read_b128 v[44:47], v236 offset:21504
ds_read_b128 v[48:51], v236 offset:2048
ds_read_b128 v[52:55], v236 offset:22528
s_waitcnt lgkmcnt(5)
v_mfma_f32_32x32x16_bf16 v[64:79], v[32:35], v[128:131], 0
v_mfma_f32_32x32x16_bf16 v[96:111], v[32:35], v[208:211], 0
s_waitcnt lgkmcnt(4)
v_mfma_f32_32x32x16_bf16 v[80:95], v[36:39], v[128:131], 0
v_mfma_f32_32x32x16_bf16 v[112:127], v[36:39], v[208:211], 0
ds_read_b128 v[56:59], v236 offset:3072
ds_read_b128 v[60:63], v236 offset:23552
s_waitcnt lgkmcnt(5)
v_mfma_f32_32x32x16_bf16 v[64:79], v[40:43], v[132:135], v[64:79]
v_mfma_f32_32x32x16_bf16 v[96:111], v[40:43], v[212:215], v[96:111]
s_waitcnt lgkmcnt(4)
v_mfma_f32_32x32x16_bf16 v[80:95], v[44:47], v[132:135], v[80:95]
v_mfma_f32_32x32x16_bf16 v[112:127], v[44:47], v[212:215], v[112:127]
ds_read_b128 v[32:35], v236 offset:4096
ds_read_b128 v[36:39], v236 offset:24576
s_waitcnt lgkmcnt(5)
v_mfma_f32_32x32x16_bf16 v[64:79], v[48:51], v[136:139], v[64:79]
v_mfma_f32_32x32x16_bf16 v[96:111], v[48:51], v[216:219], v[96:111]
s_waitcnt lgkmcnt(4)
v_mfma_f32_32x32x16_bf16 v[80:95], v[52:55], v[136:139], v[80:95]
v_mfma_f32_32x32x16_bf16 v[112:127], v[52:55], v[216:219], v[112:127]
ds_read_b128 v[40:43], v237 offset:0
ds_read_b128 v[44:47], v237 offset:20480
s_waitcnt lgkmcnt(5)
v_mfma_f32_32x32x16_bf16 v[64:79], v[56:59], v[140:143], v[64:79]
v_mfma_f32_32x32x16_bf16 v[96:111], v[56:59], v[220:223], v[96:111]
s_waitcnt lgkmcnt(4)
v_mfma_f32_32x32x16_bf16 v[80:95], v[60:63], v[140:143], v[80:95]
v_mfma_f32_32x32x16_bf16 v[112:127], v[60:63], v[220:223], v[112:127]
ds_read_b128 v[48:51], v237 offset:1024
ds_read_b128 v[52:55], v237 offset:21504
s_waitcnt lgkmcnt(5)
v_mfma_f32_32x32x16_bf16 v[64:79], v[32:35], v[144:147], v[64:79]
v_mfma_f32_32x32x16_bf16 v[96:111], v[32:35], v[224:227], v[96:111]
s_waitcnt lgkmcnt(4)
v_mfma_f32_32x32x16_bf16 v[80:95], v[36:39], v[144:147], v[80:95]
v_mfma_f32_32x32x16_bf16 v[112:127], v[36:39], v[224:227], v[112:127]
ds_read_b128 v[56:59], v237 offset:2048
ds_read_b128 v[60:63], v237 offset:22528
s_waitcnt lgkmcnt(5)
v_mfma_f32_32x32x16_bf16 v[64:79], v[40:43], v[148:151], v[64:79]
s_waitcnt lgkmcnt(4)
v_mfma_f32_32x32x16_bf16 v[80:95], v[44:47], v[148:151], v[80:95]
ds_read_b128 v[32:35], v237 offset:3072
ds_read_b128 v[36:39], v237 offset:23552
s_waitcnt lgkmcnt(5)
v_mfma_f32_32x32x16_bf16 v[64:79], v[48:51], v[152:155], v[64:79]
s_waitcnt lgkmcnt(4)
v_mfma_f32_32x32x16_bf16 v[80:95], v[52:55], v[152:155], v[80:95]
ds_read_b128 v[40:43], v237 offset:4096
ds_read_b128 v[44:47], v237 offset:24576
s_waitcnt lgkmcnt(5)
v_mfma_f32_32x32x16_bf16 v[64:79], v[56:59], v[156:159], v[64:79]
s_waitcnt lgkmcnt(4)
v_mfma_f32_32x32x16_bf16 v[80:95], v[60:63], v[156:159], v[80:95]
ds_read_b128 v[48:51], v238 offset:0
ds_read_b128 v[52:55], v238 offset:20480
s_waitcnt lgkmcnt(5)
v_mfma_f32_32x32x16_bf16 v[64:79], v[32:35], v[160:163], v[64:79]
s_waitcnt lgkmcnt(4)
v_mfma_f32_32x32x16_bf16 v[80:95], v[36:39], v[160:163], v[80:95]
ds_read_b128 v[56:59], v238 offset:1024
ds_read_b128 v[60:63], v238 offset:21504
s_waitcnt lgkmcnt(5)
v_mfma_f32_32x32x16_bf16 v[64:79], v[40:43], v[164:167], v[64:79]
s_waitcnt lgkmcnt(4)
v_mfma_f32_32x32x16_bf16 v[80:95], v[44:47], v[164:167], v[80:95]
ds_read_b128 v[32:35], v238 offset:2048
ds_read_b128 v[36:39], v238 offset:22528
s_waitcnt lgkmcnt(5)
v_mfma_f32_32x32x16_bf16 v[64:79], v[48:51], v[168:171], v[64:79]
s_waitcnt lgkmcnt(4)
v_mfma_f32_32x32x16_bf16 v[80:95], v[52:55], v[168:171], v[80:95]
ds_read_b128 v[40:43], v238 offset:3072
ds_read_b128 v[44:47], v238 offset:23552
s_waitcnt lgkmcnt(5)
v_mfma_f32_32x32x16_bf16 v[64:79], v[56:59], v[172:175], v[64:79]
s_waitcnt lgkmcnt(4)
v_mfma_f32_32x32x16_bf16 v[80:95], v[60:63], v[172:175], v[80:95]
ds_read_b128 v[48:51], v238 offset:4096
ds_read_b128 v[52:55], v238 offset:24576
s_waitcnt lgkmcnt(5)
v_mfma_f32_32x32x16_bf16 v[64:79], v[32:35], v[176:179], v[64:79]
s_waitcnt lgkmcnt(4)
v_mfma_f32_32x32x16_bf16 v[80:95], v[36:39], v[176:179], v[80:95]
ds_read_b128 v[56:59], v239 offset:0
ds_read_b128 v[60:63], v239 offset:20480
s_waitcnt lgkmcnt(5)
v_mfma_f32_32x32x16_bf16 v[64:79], v[40:43], v[180:183], v[64:79]
s_waitcnt lgkmcnt(4)
v_mfma_f32_32x32x16_bf16 v[80:95], v[44:47], v[180:183], v[80:95]
ds_read_b128 v[32:35], v239 offset:1024
ds_read_b128 v[36:39], v239 offset:21504
s_waitcnt lgkmcnt(5)
v_mfma_f32_32x32x16_bf16 v[64:79], v[48:51], v[184:187], v[64:79]
s_waitcnt lgkmcnt(4)
v_mfma_f32_32x32x16_bf16 v[80:95], v[52:55], v[184:187], v[80:95]
ds_read_b128 v[40:43], v239 offset:2048
ds_read_b128 v[44:47], v239 offset:22528
s_waitcnt lgkmcnt(5)
v_mfma_f32_32x32x16_bf16 v[64:79], v[56:59], v[188:191], v[64:79]
s_waitcnt lgkmcnt(4)
v_mfma_f32_32x32x16_bf16 v[80:95], v[60:63], v[188:191], v[80:95]
ds_read_b128 v[48:51], v239 offset:3072
ds_read_b128 v[52:55], v239 offset:23552
s_waitcnt lgkmcnt(5)
v_mfma_f32_32x32x16_bf16 v[64:79], v[32:35], v[192:195], v[64:79]
s_waitcnt lgkmcnt(4)
v_mfma_f32_32x32x16_bf16 v[80:95], v[36:39], v[192:195], v[80:95]
ds_read_b128 v[56:59], v239 offset:4096
ds_read_b128 v[60:63], v239 offset:24576
s_waitcnt lgkmcnt(5)
v_mfma_f32_32x32x16_bf16 v[64:79], v[40:43], v[196:199], v[64:79]
s_waitcnt lgkmcnt(4)
v_mfma_f32_32x32x16_bf16 v[80:95], v[44:47], v[196:199], v[80:95]
ds_read_b128 v[32:35], v253 offset:20480
s_waitcnt lgkmcnt(4)
v_mfma_f32_32x32x16_bf16 v[64:79], v[48:51], v[200:203], v[64:79]
s_waitcnt lgkmcnt(3)
v_mfma_f32_32x32x16_bf16 v[80:95], v[52:55], v[200:203], v[80:95]
s_waitcnt lgkmcnt(2)
v_mfma_f32_32x32x16_bf16 v[64:79], v[56:59], v[204:207], v[64:79]
s_waitcnt lgkmcnt(1)
v_mfma_f32_32x32x16_bf16 v[80:95], v[60:63], v[204:207], v[80:95]
s_waitcnt lgkmcnt(0)
v_and_b32 v32, 0xffff, v32
v_or_b32 v32, v32, v249
v_mov_b32 v33, v250
v_mov_b32 v34, 0
v_mov_b32 v35, 0
s_nop 1
v_mfma_f32_32x32x16_bf16 v[80:95], v[32:35], v[228:231], v[80:95]
v_mfma_f32_32x32x16_bf16 v[112:127], v[32:35], v[232:235], v[112:127]
v_cmp_gt_u32 vcc, 16, v254
v_mov_b32 v4, -1.0
s_nop 0
v_cndmask_b32 v240, v4, 1.0, vcc
s_lshl_b32 s3, s20, 7
s_add_u32 s3, s3, 40960
v_lshl_add_u32 v5, v255, 4, s3
ds_read_b128 v[128:131], v5 offset:0
ds_read_b128 v[132:135], v5 offset:32
ds_read_b128 v[136:139], v5 offset:64
ds_read_b128 v[140:143], v5 offset:96
s_nop 0
v_fma_f32 v96, v112, v240, v96
v_fma_f32 v97, v113, v240, v97
v_fma_f32 v98, v114, v240, v98
v_fma_f32 v99, v115, v240, v99
v_fma_f32 v100, v116, v240, v100
v_fma_f32 v101, v117, v240, v101
v_fma_f32 v102, v118, v240, v102
v_fma_f32 v103, v119, v240, v103
v_fma_f32 v104, v120, v240, v104
v_fma_f32 v105, v121, v240, v105
v_fma_f32 v106, v122, v240, v106
v_fma_f32 v107, v123, v240, v107
v_fma_f32 v108, v124, v240, v108
v_fma_f32 v109, v125, v240, v109
v_fma_f32 v110, v126, v240, v110
v_fma_f32 v111, v127, v240, v111
s_lshl_b32 s3, s20, 12
s_add_u32 s3, s3, 41984
v_add_u32 v6, s3, v1
ds_write_b128 v6, v[96:99] offset:0
ds_write_b128 v6, v[100:103] offset:1024
ds_write_b128 v6, v[104:107] offset:2048
ds_write_b128 v6, v[108:111] offset:3072
v_fma_f32 v64, v80, v240, v64
v_fma_f32 v65, v81, v240, v65
v_fma_f32 v66, v82, v240, v66
v_fma_f32 v67, v83, v240, v67
v_fma_f32 v68, v84, v240, v68
v_fma_f32 v69, v85, v240, v69
v_fma_f32 v70, v86, v240, v70
v_fma_f32 v71, v87, v240, v71
v_fma_f32 v72, v88, v240, v72
v_fma_f32 v73, v89, v240, v73
v_fma_f32 v74, v90, v240, v74
v_fma_f32 v75, v91, v240, v75
v_fma_f32 v76, v92, v240, v76
v_fma_f32 v77, v93, v240, v77
v_fma_f32 v78, v94, v240, v78
v_fma_f32 v79, v95, v240, v79
s_lshl_b32 s3, s20, 11
s_add_u32 s3, s3, 58368
v_lshlrev_b32 v241, 6, v254
v_lshl_add_u32 v241, v255, 4, v241
v_add_u32 v241, s3, v241
v_add_u32 v242, s3, v1
s_mul_i32 s6, s72, 20
s_mul_i32 s4, s71, 5
s_add_u32 s6, s6, s4
s_add_u32 s5, s6, s20
s_lshl_b32 s5, s5, 11
s_add_u32 s5, s5, 15728640
s_add_u32 s4, s6, 4
s_lshl_b32 s4, s4, 11
s_add_u32 s4, s4, 15728640
s_waitcnt lgkmcnt(0)
s_barrier
s_cmp_lg_u32 s20, 3
s_cbranch_scc1 l2_kernel_f1nr
v_add_u32 v6, 41984, v1
ds_read_b128 v[80:83], v6 offset:0
ds_read_b128 v[84:87], v6 offset:1024
ds_read_b128 v[88:91], v6 offset:2048
ds_read_b128 v[92:95], v6 offset:3072
ds_read_b128 v[112:115], v6 offset:4096
ds_read_b128 v[116:119], v6 offset:5120
ds_read_b128 v[120:123], v6 offset:6144
ds_read_b128 v[124:127], v6 offset:7168
ds_read_b128 v[32:35], v6 offset:8192
ds_read_b128 v[36:39], v6 offset:9216
ds_read_b128 v[40:43], v6 offset:10240
ds_read_b128 v[44:47], v6 offset:11264
l2_kernel_f1nr:
v_mul_f32 v64, v64, v128
v_mul_f32 v65, v65, v129
v_mul_f32 v66, v66, v130
v_mul_f32 v67, v67, v131
v_mul_f32 v68, v68, v132
v_mul_f32 v69, v69, v133
v_mul_f32 v70, v70, v134
v_mul_f32 v71, v71, v135
v_mul_f32 v72, v72, v136
v_mul_f32 v73, v73, v137
v_mul_f32 v74, v74, v138
v_mul_f32 v75, v75, v139
v_mul_f32 v76, v76, v140
v_mul_f32 v77, v77, v141
v_mul_f32 v78, v78, v142
v_mul_f32 v79, v79, v143
v_cvt_pk_f16_f32 v176, v64, v65
v_cvt_pk_f16_f32 v177, v66, v67
v_cvt_pk_f16_f32 v178, v68, v69
v_cvt_pk_f16_f32 v179, v70, v71
v_cvt_pk_f16_f32 v180, v72, v73
v_cvt_pk_f16_f32 v181, v74, v75
v_cvt_pk_f16_f32 v182, v76, v77
v_cvt_pk_f16_f32 v183, v78, v79
v_mfma_f32_32x32x16_f16 v[144:159], v[176:179], v[16:19], 0
v_mfma_f32_32x32x16_f16 v[160:175], v[176:179], v[24:27], 0
v_mfma_f32_32x32x16_f16 v[144:159], v[180:183], v[20:23], v[144:159]
v_mfma_f32_32x32x16_f16 v[160:175], v[180:183], v[28:31], v[160:175]
s_nop 11
v_sub_f32 v64, v144, v168
v_add_f32 v72, v160, v152
v_sub_f32 v65, v145, v169
v_add_f32 v73, v161, v153
v_sub_f32 v66, v146, v170
v_add_f32 v74, v162, v154
v_sub_f32 v67, v147, v171
v_add_f32 v75, v163, v155
v_sub_f32 v68, v148, v172
v_add_f32 v76, v164, v156
v_sub_f32 v69, v149, v173
v_add_f32 v77, v165, v157
v_sub_f32 v70, v150, v174
v_add_f32 v78, v166, v158
v_sub_f32 v71, v151, v175
v_add_f32 v79, v167, v159
v_cvt_pk_f16_f32 v176, v64, v65
v_cvt_pk_f16_f32 v180, v72, v73
v_cvt_pk_f16_f32 v177, v66, v67
v_cvt_pk_f16_f32 v181, v74, v75
v_cvt_pk_f16_f32 v178, v68, v69
v_cvt_pk_f16_f32 v182, v76, v77
v_cvt_pk_f16_f32 v179, v70, v71
v_cvt_pk_f16_f32 v183, v78, v79
ds_write_b128 v241, v[176:179]
ds_write_b128 v241, v[180:183] offset:32
s_waitcnt lgkmcnt(0)
ds_read_b128 v[176:179], v242
ds_read_b128 v[180:183], v242 offset:1024
s_waitcnt lgkmcnt(0)
buffer_store_dwordx4 v[176:179], v1, s[8:11], s5 offen sc1
buffer_store_dwordx4 v[180:183], v1, s[8:11], s5 offen offset:1024 sc1
s_cmp_lg_u32 s20, 3
s_cbranch_scc1 l2_kernel_f1done
s_waitcnt lgkmcnt(0)
v_add_f32 v96, v96, v80
v_add_f32 v97, v97, v81
v_add_f32 v98, v98, v82
v_add_f32 v99, v99, v83
v_add_f32 v100, v100, v84
v_add_f32 v101, v101, v85
v_add_f32 v102, v102, v86
v_add_f32 v103, v103, v87
v_add_f32 v104, v104, v88
v_add_f32 v105, v105, v89
v_add_f32 v106, v106, v90
v_add_f32 v107, v107, v91
v_add_f32 v108, v108, v92
v_add_f32 v109, v109, v93
v_add_f32 v110, v110, v94
v_add_f32 v111, v111, v95
v_add_f32 v96, v96, v112
v_add_f32 v97, v97, v113
v_add_f32 v98, v98, v114
v_add_f32 v99, v99, v115
v_add_f32 v100, v100, v116
v_add_f32 v101, v101, v117
v_add_f32 v102, v102, v118
v_add_f32 v103, v103, v119
v_add_f32 v104, v104, v120
v_add_f32 v105, v105, v121
v_add_f32 v106, v106, v122
v_add_f32 v107, v107, v123
v_add_f32 v108, v108, v124
v_add_f32 v109, v109, v125
v_add_f32 v110, v110, v126
v_add_f32 v111, v111, v127
v_add_f32 v96, v96, v32
v_add_f32 v97, v97, v33
v_add_f32 v98, v98, v34
v_add_f32 v99, v99, v35
v_add_f32 v100, v100, v36
v_add_f32 v101, v101, v37
v_add_f32 v102, v102, v38
v_add_f32 v103, v103, v39
v_add_f32 v104, v104, v40
v_add_f32 v105, v105, v41
v_add_f32 v106, v106, v42
v_add_f32 v107, v107, v43
v_add_f32 v108, v108, v44
v_add_f32 v109, v109, v45
v_add_f32 v110, v110, v46
v_add_f32 v111, v111, v47
v_mul_f32 v96, v96, v128
v_mul_f32 v97, v97, v129
v_mul_f32 v98, v98, v130
v_mul_f32 v99, v99, v131
v_mul_f32 v100, v100, v132
v_mul_f32 v101, v101, v133
v_mul_f32 v102, v102, v134
v_mul_f32 v103, v103, v135
v_mul_f32 v104, v104, v136
v_mul_f32 v105, v105, v137
v_mul_f32 v106, v106, v138
v_mul_f32 v107, v107, v139
v_mul_f32 v108, v108, v140
v_mul_f32 v109, v109, v141
v_mul_f32 v110, v110, v142
v_mul_f32 v111, v111, v143
v_cvt_pk_f16_f32 v184, v96, v97
v_cvt_pk_f16_f32 v185, v98, v99
v_cvt_pk_f16_f32 v186, v100, v101
v_cvt_pk_f16_f32 v187, v102, v103
v_cvt_pk_f16_f32 v188, v104, v105
v_cvt_pk_f16_f32 v189, v106, v107
v_cvt_pk_f16_f32 v190, v108, v109
v_cvt_pk_f16_f32 v191, v110, v111
v_mfma_f32_32x32x16_f16 v[144:159], v[184:187], v[16:19], 0
v_mfma_f32_32x32x16_f16 v[160:175], v[184:187], v[24:27], 0
v_mfma_f32_32x32x16_f16 v[144:159], v[188:191], v[20:23], v[144:159]
v_mfma_f32_32x32x16_f16 v[160:175], v[188:191], v[28:31], v[160:175]
s_nop 11
v_sub_f32 v96, v144, v168
v_add_f32 v104, v160, v152
v_sub_f32 v97, v145, v169
v_add_f32 v105, v161, v153
v_sub_f32 v98, v146, v170
v_add_f32 v106, v162, v154
v_sub_f32 v99, v147, v171
v_add_f32 v107, v163, v155
v_sub_f32 v100, v148, v172
v_add_f32 v108, v164, v156
v_sub_f32 v101, v149, v173
v_add_f32 v109, v165, v157
v_sub_f32 v102, v150, v174
v_add_f32 v110, v166, v158
v_sub_f32 v103, v151, v175
v_add_f32 v111, v167, v159
v_cvt_pk_f16_f32 v184, v96, v97
v_cvt_pk_f16_f32 v188, v104, v105
v_cvt_pk_f16_f32 v185, v98, v99
v_cvt_pk_f16_f32 v189, v106, v107
v_cvt_pk_f16_f32 v186, v100, v101
v_cvt_pk_f16_f32 v190, v108, v109
v_cvt_pk_f16_f32 v187, v102, v103
v_cvt_pk_f16_f32 v191, v110, v111
ds_write_b128 v241, v[184:187]
ds_write_b128 v241, v[188:191] offset:32
s_waitcnt lgkmcnt(0)
ds_read_b128 v[184:187], v242
ds_read_b128 v[188:191], v242 offset:1024
s_waitcnt lgkmcnt(0)
buffer_store_dwordx4 v[184:187], v1, s[8:11], s4 offen sc1
buffer_store_dwordx4 v[188:191], v1, s[8:11], s4 offen offset:1024 sc1
l2_kernel_f1done:
s_waitcnt lgkmcnt(0)
s_waitcnt vmcnt(0)
s_barrier
s_lshl_b32 s3, s71, 2
s_and_b32 s4, s70, 3
s_add_u32 s3, s3, s4
s_lshl_b32 s3, s3, 8
s_add_u32 s25, s3, 43548672
s_cmp_lg_u32 s20, 0
s_cbranch_scc1 l2_kernel_sigV
v_mov_b32 v10, 0
v_mov_b32 v11, 1
s_mov_b64 exec, 1
buffer_atomic_add v11, v10, s[8:11], s25 offen sc1
s_mov_b64 exec, -1
l2_kernel_sigV:
s_mul_i32 s34, s20, 5120
s_mul_i32 s79, s22, 27
s_lshr_b32 s79, s79, 2
s_add_u32 s4, s22, 1
s_mul_i32 s4, s4, 27
s_lshr_b32 s4, s4, 2
s_sub_u32 s37, s4, s79
s_mul_i32 s35, s79, 40960
s_add_u32 s35, s35, 33554432
s_lshl_b32 s5, s21, 2
s_add_u32 s5, s5, s20
s_mul_i32 s36, s5, 110592
s_lshl_b32 s4, s79, 9
s_add_u32 s36, s36, s4
s_add_u32 s36, s36, 18874368
s_add_u32 s36, s36, s74
s_mul_i32 s38, s5, 40960
s_add_u32 s38, s38, 3145728
s_add_u32 s38, s38, s69
s_mul_i32 s39, s5, 5120
s_add_u32 s39, s39, 42205184
s_add_u32 s39, s39, s75
s_mov_b32 s76, 1
s_add_u32 s4, s34, s35
s_add_u32 s4, s4, 0
s_add_u32 m0, s34, 0
s_nop 0
buffer_load_dwordx4 v1, s[8:11], s4 offen  lds
buffer_load_dwordx4 v1, s[8:11], s4 offen offset:1024  lds
buffer_load_dwordx4 v1, s[8:11], s4 offen offset:2048  lds
buffer_load_dwordx4 v1, s[8:11], s4 offen offset:3072  lds
s_add_u32 s4, s4, 4096
s_add_u32 m0, m0, 4096
s_nop 0
buffer_load_dwordx4 v1, s[8:11], s4 offen  lds
s_add_u32 s4, s34, s35
s_add_u32 s4, s4, 40960
s_add_u32 m0, s34, 40960
s_nop 0
buffer_load_dwordx4 v1, s[8:11], s4 offen  lds
buffer_load_dwordx4 v1, s[8:11], s4 offen offset:1024  lds
buffer_load_dwordx4 v1, s[8:11], s4 offen offset:2048  lds
buffer_load_dwordx4 v1, s[8:11], s4 offen offset:3072  lds
s_add_u32 s4, s4, 4096
s_add_u32 m0, m0, 4096
s_nop 0
buffer_load_dwordx4 v1, s[8:11], s4 offen  lds
s_add_u32 s4, s34, s35
s_add_u32 s4, s4, 20480
s_add_u32 m0, s34, 20480
s_nop 0
buffer_load_dwordx4 v1, s[8:11], s4 offen  lds
buffer_load_dwordx4 v1, s[8:11], s4 offen offset:1024  lds
buffer_load_dwordx4 v1, s[8:11], s4 offen offset:2048  lds
buffer_load_dwordx4 v1, s[8:11], s4 offen offset:3072  lds
s_add_u32 s4, s4, 4096
s_add_u32 m0, m0, 4096
s_nop 0
buffer_load_dwordx4 v1, s[8:11], s4 offen  lds
s_add_u32 s4, s34, s35
s_add_u32 s4, s4, 61440
s_add_u32 m0, s34, 61440
s_nop 0
buffer_load_dwordx4 v1, s[8:11], s4 offen  lds
buffer_load_dwordx4 v1, s[8:11], s4 offen offset:1024  lds
buffer_load_dwordx4 v1, s[8:11], s4 offen offset:2048  lds
buffer_load_dwordx4 v1, s[8:11], s4 offen offset:3072  lds
s_add_u32 s4, s4, 4096
s_add_u32 m0, m0, 4096
s_nop 0
buffer_load_dwordx4 v1, s[8:11], s4 offen  lds
s_add_u32 s4, s34, s35
s_add_u32 s4, s4, 81920
s_add_u32 m0, s34, 81920
s_nop 0
buffer_load_dwordx4 v1, s[8:11], s4 offen  lds
buffer_load_dwordx4 v1, s[8:11], s4 offen offset:1024  lds
buffer_load_dwordx4 v1, s[8:11], s4 offen offset:2048  lds
buffer_load_dwordx4 v1, s[8:11], s4 offen offset:3072  lds
s_add_u32 s4, s4, 4096
s_add_u32 m0, m0, 4096
s_nop 0
buffer_load_dwordx4 v1, s[8:11], s4 offen  lds
s_add_u32 s4, s34, s35
s_add_u32 s4, s4, 102400
s_add_u32 m0, s34, 102400
s_nop 0
buffer_load_dwordx4 v1, s[8:11], s4 offen  lds
buffer_load_dwordx4 v1, s[8:11], s4 offen offset:1024  lds
buffer_load_dwordx4 v1, s[8:11], s4 offen offset:2048  lds
buffer_load_dwordx4 v1, s[8:11], s4 offen offset:3072  lds
s_add_u32 s4, s4, 4096
s_add_u32 m0, m0, 4096
s_nop 0
buffer_load_dwordx4 v1, s[8:11], s4 offen  lds
l2_kernel_vtd:
s_mov_b32 s67, 1
s_cmp_ge_u32 s78, 10
s_cbranch_scc1 l2_kernel_layer
s_cmp_lg_u32 s20, 0
s_cbranch_scc1 l2_kernel_vwait
s_mov_b32 s7, 0
v_and_b32 v10, 15, v0
v_lshlrev_b32 v10, 8, v10
s_mov_b32 s24, 43548672
l2_kernel_pv_retry:
buffer_load_dword v11, v10, s[8:11], s24 offen sc1
s_waitcnt vmcnt(0)
v_cmp_gt_u32 vcc, 16, v11
s_nop 4
s_cbranch_vccz l2_kernel_vwait
s_add_u32 s7, s7, 1
s_cmp_lt_u32 s7, 400000
s_cbranch_scc0 l2_kernel_vwait
s_branch l2_kernel_pv_retry
l2_kernel_vwait:
s_barrier
s_branch l2_kernel_layer
l2_kernel_final:
s_mov_b32 s16, s100
s_mov_b32 s17, s101
s_mov_b32 s18, 2621440
s_mov_b32 s19, 0x20000
s_waitcnt vmcnt(0)
v_lshlrev_b32 v16, 16, v112
v_and_b32 v17, 0xffff0000, v112
v_add_f32 v16, v16, v32
v_add_f32 v17, v17, v33
v_cvt_pk_bf16_f32 v112, v16, v17
v_lshlrev_b32 v16, 16, v113
v_and_b32 v17, 0xffff0000, v113
v_add_f32 v16, v16, v34
v_add_f32 v17, v17, v35
v_cvt_pk_bf16_f32 v113, v16, v17
v_lshlrev_b32 v16, 16, v114
v_and_b32 v17, 0xffff0000, v114
v_add_f32 v16, v16, v36
v_add_f32 v17, v17, v37
v_cvt_pk_bf16_f32 v114, v16, v17
v_lshlrev_b32 v16, 16, v115
v_and_b32 v17, 0xffff0000, v115
v_add_f32 v16, v16, v38
v_add_f32 v17, v17, v39
v_cvt_pk_bf16_f32 v115, v16, v17
v_lshlrev_b32 v16, 16, v116
v_and_b32 v17, 0xffff0000, v116
v_add_f32 v16, v16, v40
v_add_f32 v17, v17, v41
v_cvt_pk_bf16_f32 v116, v16, v17
v_lshlrev_b32 v16, 16, v117
v_and_b32 v17, 0xffff0000, v117
v_add_f32 v16, v16, v42
v_add_f32 v17, v17, v43
v_cvt_pk_bf16_f32 v117, v16, v17
v_lshlrev_b32 v16, 16, v118
v_and_b32 v17, 0xffff0000, v118
v_add_f32 v16, v16, v44
v_add_f32 v17, v17, v45
v_cvt_pk_bf16_f32 v118, v16, v17
v_lshlrev_b32 v16, 16, v119
v_and_b32 v17, 0xffff0000, v119
v_add_f32 v16, v16, v46
v_add_f32 v17, v17, v47
v_cvt_pk_bf16_f32 v119, v16, v17
v_lshlrev_b32 v16, 16, v120
v_and_b32 v17, 0xffff0000, v120
v_add_f32 v16, v16, v48
v_add_f32 v17, v17, v49
v_cvt_pk_bf16_f32 v120, v16, v17
v_lshlrev_b32 v16, 16, v121
v_and_b32 v17, 0xffff0000, v121
v_add_f32 v16, v16, v50
v_add_f32 v17, v17, v51
v_cvt_pk_bf16_f32 v121, v16, v17
v_lshlrev_b32 v18, 6, v13
v_add_u32 v18, s65, v18
v_mul_u32_u24 v18, 1280, v18
s_cmp_ge_u32 s23, 4
s_cbranch_scc1 l2_kernelf_mir
s_mul_i32 s3, s23, 160
v_lshl_add_u32 v16, v3, 4, v18
v_lshl_add_u32 v17, v3, 3, v18
buffer_store_dwordx4 v[112:115], v16, s[16:19], s3 offen
buffer_store_dwordx4 v[116:119], v16, s[16:19], s3 offen offset:64
buffer_store_dwordx2 v[120:121], v17, s[16:19], s3 offen offset:128
s_branch l2_kernelf_outdone
l2_kernelf_mir:
s_mul_i32 s3, s23, 160
s_sub_u32 s3, 1908, s3
v_lshlrev_b32 v16, 4, v3
v_sub_u32 v16, v18, v16
v_add_u32 v16, s3, v16
s_mov_b32 s4, 0x07060100
v_perm_b32 v96, v114, v115, s4
v_perm_b32 v97, v113, v114, s4
v_perm_b32 v98, v112, v113, s4
v_subrev_u32 v17, 0, v16
buffer_store_dwordx3 v[96:98], v17, s[16:19], 0 offen
v_subrev_u32 v100, 2, v17
buffer_store_short_d16_hi v115, v100, s[16:19], 0 offen
v_add_u32 v100, 12, v17
v_add_u32 v101, 640, v18
s_cmp_eq_u32 s23, 4
s_cselect_b32 s5, 0, 1
v_or_b32 v102, s5, v3
v_cmp_eq_u32 vcc, 0, v102
s_nop 1
v_cndmask_b32 v100, v100, v101, vcc
buffer_store_short v112, v100, s[16:19], 0 offen
s_nop 1
v_perm_b32 v96, v118, v119, s4
v_perm_b32 v97, v117, v118, s4
v_perm_b32 v98, v116, v117, s4
v_subrev_u32 v17, 64, v16
buffer_store_dwordx3 v[96:98], v17, s[16:19], 0 offen
v_subrev_u32 v100, 2, v17
buffer_store_short_d16_hi v119, v100, s[16:19], 0 offen
v_add_u32 v100, 12, v17
buffer_store_short v116, v100, s[16:19], 0 offen
s_nop 1
s_mul_i32 s3, s23, 160
s_sub_u32 s3, 1788, s3
v_lshlrev_b32 v17, 3, v3
v_sub_u32 v17, v18, v17
v_add_u32 v17, s3, v17
v_perm_b32 v96, v120, v121, s4
buffer_store_dword v96, v17, s[16:19], 0 offen
v_subrev_u32 v100, 2, v17
buffer_store_short_d16_hi v121, v100, s[16:19], 0 offen
v_add_u32 v101, 4, v17
buffer_store_short v120, v101, s[16:19], 0 offen
l2_kernelf_outdone:
l2_kernel_end:
s_endpgm
.section .rodata,"a"
.p2align 6
.amdhsa_kernel l2_kernel
  .amdhsa_next_free_vgpr 512
  .amdhsa_next_free_sgpr 102
  .amdhsa_accum_offset 256
  .amdhsa_group_segment_fixed_size 0
  .amdhsa_kernarg_size 96
  .amdhsa_user_sgpr_count 2
  .amdhsa_user_sgpr_kernarg_segment_ptr 1
  .amdhsa_system_sgpr_workgroup_id_x 1
.end_amdhsa_kernel
```
